```python
import torch

def _softmax(x, axis=-1):
    return torch.softmax(x, dim=axis)
def _gelu(x):
    return torch.nn.functional.gelu(x, approximate="tanh")
def _silu(x):
    return torch.nn.functional.silu(x)
def _sigmoid(x):
    return torch.sigmoid(x)
def _layernorm(x, axis=-1, eps=1e-5):
    m = x.mean(dim=axis, keepdim=True)
    v = x.var(dim=axis, keepdim=True, unbiased=False)
    return (x - m) / torch.sqrt(v + eps)
def _scatter_add(tgt, idx, src, axis=0):
    return tgt.clone().index_add_(axis, idx, src)
def _segment_sum(src, seg, n):
    out = torch.zeros((n,) + src.shape[1:], dtype=src.dtype)
    return out.index_add_(0, seg, src)
def _pad(x, pw):
    flat = tuple(v for pair in reversed(pw) for v in pair)
    return torch.nn.functional.pad(x, flat)

kernel_name = 'concat_heads__gqa_block_cached__mha_block_cached__decode'

def setup_inputs():

    _w = (lambda a: (lambda t: t.to(torch.bfloat16) if t.is_floating_point() else t)(torch.as_tensor(a)))
    def _A_setup():
        B, Sq, D = 2, 1, 576
        Hq, Hkv, Sk, Dh = 32, 16, 8192, 128
        assert Hq % Hkv == 0, (Hq, Hkv)
        return {
            "x": _w((lambda *s: torch.randn(*s, dtype=torch.bfloat16) * 0.8)(B, Sq, D)),
            "k_cache": _w((lambda *s: torch.randn(*s, dtype=torch.bfloat16) * 0.8)(B, Hkv, Sk, Dh)),
            "v_cache": _w((lambda *s: torch.randn(*s, dtype=torch.bfloat16) * 0.05)(B, Hkv, Sk, Dh)),
            "wq": _w((lambda *s: torch.randn(*s, dtype=torch.bfloat16) * 0.8)(D, Hq * Dh) * (D ** -0.5)),
            "wo": _w((lambda *s: torch.randn(*s, dtype=torch.bfloat16) * 0.05)(Hq * Dh, D) * ((Hq * Dh) ** -0.5)),
        }
    _A_in = _A_setup()

    def _B_setup():
        B, Sq, D = 2, 1, 576
        H, Sk, Dh = 32, 8192, 128
        return {
            "x": _w((lambda *s: torch.randn(*s, dtype=torch.bfloat16) * 0.8)(B, Sq, D)),
            "k_cache": _w((lambda *s: torch.randn(*s, dtype=torch.bfloat16) * 0.8)(B, H, Sk, Dh)),
            "v_cache": _w((lambda *s: torch.randn(*s, dtype=torch.bfloat16) * 0.05)(B, H, Sk, Dh)),
            "wq": _w((lambda *s: torch.randn(*s, dtype=torch.bfloat16) * 0.8)(D, H * Dh) * (D ** -0.5)),
            "wo": _w((lambda *s: torch.randn(*s, dtype=torch.bfloat16) * 0.05)(H * Dh, D) * ((H * Dh) ** -0.5)),
        }
    _B_in = _B_setup()

    return {
        "A_x": _A_in["x"],
        "A_k_cache": _A_in["k_cache"],
        "A_v_cache": _A_in["v_cache"],
        "A_wq": _A_in["wq"],
        "A_wo": _A_in["wo"],
        "B_x": _B_in["x"],
        "B_k_cache": _B_in["k_cache"],
        "B_v_cache": _B_in["v_cache"],
        "B_wq": _B_in["wq"],
        "B_wo": _B_in["wo"],
    }

def reference(A_x, A_k_cache, A_v_cache, A_wq, A_wo, B_x, B_k_cache, B_v_cache, B_wq, B_wo):
    def _A_ref(x, k_cache, v_cache, wq, wo):
        B, Sq, D = x.shape
        Hq, Dh = 32, 128
        Hkv = k_cache.shape[1]
        rep = Hq // Hkv
        q = (lambda x, *d: x.permute(*d))((x @ wq).reshape(B, Sq, Hq, Dh), 0, 2, 1, 3)
        k = (lambda x, n, axis: torch.repeat_interleave(x, n, dim=axis))(k_cache, rep, axis=1)
        v = (lambda x, n, axis: torch.repeat_interleave(x, n, dim=axis))(v_cache, rep, axis=1)
        scores = torch.einsum("bhqd,bhkd->bhqk", q, k) * (Dh ** -0.5)
        p = _softmax(scores, axis=-1)
        o = torch.einsum("bhqk,bhkd->bhqd", p, v)
        return (lambda x, *d: x.permute(*d))(o, 0, 2, 1, 3).reshape(B, Sq, Hq * Dh) @ wo

    def _B_ref(x, k_cache, v_cache, wq, wo):
        B, Sq, D = x.shape
        H, Dh = 32, 128
        q = (lambda x, *d: x.permute(*d))((x @ wq).reshape(B, Sq, H, Dh), 0, 2, 1, 3)
        scores = torch.einsum("bhqd,bhkd->bhqk", q, k_cache) * (Dh ** -0.5)
        p = _softmax(scores, axis=-1)
        o = torch.einsum("bhqk,bhkd->bhqd", p, v_cache)
        return (lambda x, *d: x.permute(*d))(o, 0, 2, 1, 3).reshape(B, Sq, H * Dh) @ wo

    a = _A_ref(A_x, A_k_cache, A_v_cache, A_wq, A_wo)
    b = _B_ref(B_x, B_k_cache, B_v_cache, B_wq, B_wo)
    return torch.concatenate([a, b], axis=-1)
```

```asm
; @launch grid=(256,1,1) block=(256,1,1) lds=2048
.amdgcn_target "amdgcn-amd-amdhsa--gfx950"
.text
.globl concat_heads__gqa_block_cached__mha_block_cached__decode_kernel
.p2align 8
.type concat_heads__gqa_block_cached__mha_block_cached__decode_kernel,@function
concat_heads__gqa_block_cached__mha_block_cached__decode_kernel:
    s_cmp_ge_u32 s2, 256
    s_cbranch_scc1 L_end
    s_load_dwordx2 s[60:61], s[0:1], 96
    s_load_dwordx16 s[36:51], s[0:1], 0
    s_load_dwordx8 s[52:59], s[0:1], 64
    v_lshrrev_b32 v26, 6, v0
    v_and_b32 v1, 63, v0
    v_readfirstlane_b32 s3, v26
    v_and_b32 v2, 15, v0
    v_lshrrev_b32 v3, 4, v1
    s_cmp_lg_u32 s3, 3
    s_cbranch_scc1 L_stream
    s_mov_b32 s7, 0x00020000
    s_mov_b32 s11, 0x00020000
    s_mov_b32 s15, 0x00020000
    s_mov_b32 s19, 0x00020000
    s_mov_b32 s23, 0x00020000
    s_mov_b32 s27, 0x00020000
    s_mov_b32 s26, 33554432
    s_bfe_u32 s63, s2, 0x50002
    s_and_b32 s64, s2, 3
    s_mul_i32 s65, s64, 144
    v_mul_u32_u24 v26, 36, v3
    v_add_u32 v26, s65, v26
    v_lshrrev_b32 v27, 3, v2
    v_mul_u32_u24 v27, 1152, v27
    v_lshl_add_u32 v27, v26, 1, v27
    v_lshlrev_b32 v26, 13, v26
    v_lshl_add_u32 v26, v2, 4, v26
    s_lshl_b32 s30, s63, 8
    s_mov_b32 s18, 2304
    s_mov_b32 s14, 4718592
    s_mov_b32 s6, 4718592
    s_mov_b32 s22, 4608
    s_waitcnt lgkmcnt(0)
    s_load_dword s31, s[60:61], 0
    s_mov_b32 s24, s60
    s_mov_b32 s25, s61
    s_cmp_lt_u32 s2, 128
    s_cselect_b32 s12, s42, s52
    s_cselect_b32 s13, s43, s53
    s_cselect_b32 s16, s36, s46
    s_cselect_b32 s17, s37, s47
    s_cselect_b32 s4, s44, s54
    s_cselect_b32 s5, s45, s55
    s_mov_b32 s20, s56
    s_mov_b32 s21, s57
    buffer_load_dwordx4 v[208:211], v27, s[16:19], 0 offen offset:0
    buffer_load_dwordx4 v[212:215], v27, s[16:19], 0 offen offset:16
    buffer_load_dwordx4 v[216:219], v27, s[16:19], 0 offen offset:32
    buffer_load_dwordx4 v[220:223], v27, s[16:19], 0 offen offset:48
    buffer_load_dwordx2 v[224:225], v27, s[16:19], 0 offen offset:64
    buffer_load_dwordx4 v[64:67], v26, s[12:15], s30 offen nt
    s_add_u32 s30, s30, 8192
    buffer_load_dwordx4 v[68:71], v26, s[12:15], s30 offen nt
    s_add_u32 s30, s30, 8192
    buffer_load_dwordx4 v[72:75], v26, s[12:15], s30 offen nt
    s_add_u32 s30, s30, 8192
    buffer_load_dwordx4 v[76:79], v26, s[12:15], s30 offen nt
    s_add_u32 s30, s30, 8192
    buffer_load_dwordx4 v[80:83], v26, s[12:15], s30 offen nt
    s_add_u32 s30, s30, 8192
    buffer_load_dwordx4 v[84:87], v26, s[12:15], s30 offen nt
    s_add_u32 s30, s30, 8192
    buffer_load_dwordx4 v[88:91], v26, s[12:15], s30 offen nt
    s_add_u32 s30, s30, 8192
    buffer_load_dwordx4 v[92:95], v26, s[12:15], s30 offen nt
    s_add_u32 s30, s30, 8192
    buffer_load_dwordx4 v[96:99], v26, s[12:15], s30 offen nt
    s_add_u32 s30, s30, 8192
    buffer_load_dwordx4 v[100:103], v26, s[12:15], s30 offen nt
    s_add_u32 s30, s30, 8192
    buffer_load_dwordx4 v[104:107], v26, s[12:15], s30 offen nt
    s_add_u32 s30, s30, 8192
    buffer_load_dwordx4 v[108:111], v26, s[12:15], s30 offen nt
    s_add_u32 s30, s30, 8192
    buffer_load_dwordx4 v[112:115], v26, s[12:15], s30 offen nt
    s_add_u32 s30, s30, 8192
    buffer_load_dwordx4 v[116:119], v26, s[12:15], s30 offen nt
    s_add_u32 s30, s30, 8192
    buffer_load_dwordx4 v[120:123], v26, s[12:15], s30 offen nt
    s_add_u32 s30, s30, 8192
    buffer_load_dwordx4 v[124:127], v26, s[12:15], s30 offen nt
    s_add_u32 s30, s30, 8192
    buffer_load_dwordx4 v[128:131], v26, s[12:15], s30 offen nt
    s_add_u32 s30, s30, 8192
    buffer_load_dwordx4 v[132:135], v26, s[12:15], s30 offen nt
    s_add_u32 s30, s30, 8192
    buffer_load_dwordx4 v[136:139], v26, s[12:15], s30 offen nt
    s_add_u32 s30, s30, 8192
    buffer_load_dwordx4 v[140:143], v26, s[12:15], s30 offen nt
    s_add_u32 s30, s30, 8192
    buffer_load_dwordx4 v[144:147], v26, s[12:15], s30 offen nt
    s_add_u32 s30, s30, 8192
    buffer_load_dwordx4 v[148:151], v26, s[12:15], s30 offen nt
    s_add_u32 s30, s30, 8192
    buffer_load_dwordx4 v[152:155], v26, s[12:15], s30 offen nt
    s_add_u32 s30, s30, 8192
    buffer_load_dwordx4 v[156:159], v26, s[12:15], s30 offen nt
    s_add_u32 s30, s30, 8192
    buffer_load_dwordx4 v[160:163], v26, s[12:15], s30 offen nt
    s_add_u32 s30, s30, 8192
    buffer_load_dwordx4 v[164:167], v26, s[12:15], s30 offen nt
    s_add_u32 s30, s30, 8192
    buffer_load_dwordx4 v[168:171], v26, s[12:15], s30 offen nt
    s_add_u32 s30, s30, 8192
    buffer_load_dwordx4 v[172:175], v26, s[12:15], s30 offen nt
    s_add_u32 s30, s30, 8192
    buffer_load_dwordx4 v[176:179], v26, s[12:15], s30 offen nt
    s_add_u32 s30, s30, 8192
    buffer_load_dwordx4 v[180:183], v26, s[12:15], s30 offen nt
    s_add_u32 s30, s30, 8192
    buffer_load_dwordx4 v[184:187], v26, s[12:15], s30 offen nt
    s_add_u32 s30, s30, 8192
    buffer_load_dwordx4 v[188:191], v26, s[12:15], s30 offen nt
    s_add_u32 s30, s30, 8192
    buffer_load_dwordx4 v[192:195], v26, s[12:15], s30 offen nt
    s_add_u32 s30, s30, 8192
    buffer_load_dwordx4 v[196:199], v26, s[12:15], s30 offen nt
    s_add_u32 s30, s30, 8192
    buffer_load_dwordx4 v[200:203], v26, s[12:15], s30 offen nt
    s_add_u32 s30, s30, 8192
    buffer_load_dwordx4 v[204:207], v26, s[12:15], s30 offen nt
    s_barrier
    v_mov_b32 v63, 0xff
    s_mov_b32 s32, 0x3e0293ee
    s_mov_b32 s33, 0xff61b1e6
    s_mov_b32 s34, 0x01000100
    s_mov_b32 s35, 0x03020302
    v_and_b32 v30, 1, v2
    v_lshlrev_b32 v30, 4, v30
    v_mov_b32 v31, 0xffff
    v_lshlrev_b32 v31, v30, v31
    v_bfe_u32 v30, v2, 1, 2
    v_cmp_eq_u32 vcc, 0, v30
    s_nop 1
    v_cndmask_b32 v4, 0, v31, vcc
    v_cmp_eq_u32 vcc, 1, v30
    s_nop 1
    v_cndmask_b32 v5, 0, v31, vcc
    v_cmp_eq_u32 vcc, 2, v30
    s_nop 1
    v_cndmask_b32 v6, 0, v31, vcc
    v_cmp_eq_u32 vcc, 3, v30
    s_nop 1
    v_cndmask_b32 v7, 0, v31, vcc
    s_lshr_b32 s65, s2, 3
    s_and_b32 s66, s65, 15
    s_lshr_b32 s65, s65, 4
    s_lshl_b32 s66, s66, 13
    s_lshl_b32 s65, s65, 7
    s_add_u32 s66, s66, s65
    s_add_u32 s80, s66, 4096
    s_add_u32 s81, s80, 4096
    s_add_u32 s82, s80, 131072
    s_add_u32 s83, s80, 135168
    v_lshrrev_b32 v50, 5, v1
    v_lshlrev_b32 v50, 10, v50
    v_bfe_u32 v28, v1, 3, 2
    v_lshl_add_u32 v50, v28, 8, v50
    v_and_b32 v29, 7, v1
    v_lshl_add_u32 v50, v29, 4, v50
    v_lshl_add_u32 v51, v28, 5, v29
    v_lshlrev_b32 v51, 1, v51
    v_lshlrev_b32 v52, 4, v1
    s_waitcnt vmcnt(30) lgkmcnt(0)
    s_add_u32 s31, s31, 1
    s_mul_i32 s70, s31, 0x9e3779b1
    s_lshr_b32 s71, s70, 8
    s_lshr_b32 s72, s70, 16
    s_lshr_b32 s73, s70, 24
    s_and_b32 s78, s31, 0x3fffff
    v_perm_b32 v30, v208, v208, s34
    v_and_b32 v18, v30, v4
    v_and_b32 v19, v30, v5
    v_and_b32 v20, v30, v6
    v_and_b32 v21, v30, v7
    s_nop 1
    v_mfma_f32_16x16x32_bf16 v[14:17], v[64:67], v[18:21], 0
    v_perm_b32 v31, v208, v208, s35
    v_and_b32 v22, v31, v4
    v_and_b32 v23, v31, v5
    v_and_b32 v24, v31, v6
    v_and_b32 v25, v31, v7
    s_nop 1
    v_mfma_f32_16x16x32_bf16 v[8:11], v[68:71], v[22:25], 0
    v_perm_b32 v30, v209, v209, s34
    v_and_b32 v18, v30, v4
    v_and_b32 v19, v30, v5
    v_and_b32 v20, v30, v6
    v_and_b32 v21, v30, v7
    s_nop 1
    v_mfma_f32_16x16x32_bf16 v[14:17], v[72:75], v[18:21], v[14:17]
    v_perm_b32 v31, v209, v209, s35
    v_and_b32 v22, v31, v4
    v_and_b32 v23, v31, v5
    v_and_b32 v24, v31, v6
    v_and_b32 v25, v31, v7
    s_nop 1
    v_mfma_f32_16x16x32_bf16 v[8:11], v[76:79], v[22:25], v[8:11]
    v_perm_b32 v30, v210, v210, s34
    v_and_b32 v18, v30, v4
    v_and_b32 v19, v30, v5
    v_and_b32 v20, v30, v6
    v_and_b32 v21, v30, v7
    s_nop 1
    v_mfma_f32_16x16x32_bf16 v[14:17], v[80:83], v[18:21], v[14:17]
    v_perm_b32 v31, v210, v210, s35
    v_and_b32 v22, v31, v4
    v_and_b32 v23, v31, v5
    v_and_b32 v24, v31, v6
    v_and_b32 v25, v31, v7
    s_nop 1
    v_mfma_f32_16x16x32_bf16 v[8:11], v[84:87], v[22:25], v[8:11]
    s_waitcnt vmcnt(24)
    v_perm_b32 v30, v211, v211, s34
    v_and_b32 v18, v30, v4
    v_and_b32 v19, v30, v5
    v_and_b32 v20, v30, v6
    v_and_b32 v21, v30, v7
    s_nop 1
    v_mfma_f32_16x16x32_bf16 v[14:17], v[88:91], v[18:21], v[14:17]
    v_perm_b32 v31, v211, v211, s35
    v_and_b32 v22, v31, v4
    v_and_b32 v23, v31, v5
    v_and_b32 v24, v31, v6
    v_and_b32 v25, v31, v7
    s_nop 1
    v_mfma_f32_16x16x32_bf16 v[8:11], v[92:95], v[22:25], v[8:11]
    v_perm_b32 v30, v212, v212, s34
    v_and_b32 v18, v30, v4
    v_and_b32 v19, v30, v5
    v_and_b32 v20, v30, v6
    v_and_b32 v21, v30, v7
    s_nop 1
    v_mfma_f32_16x16x32_bf16 v[14:17], v[96:99], v[18:21], v[14:17]
    v_perm_b32 v31, v212, v212, s35
    v_and_b32 v22, v31, v4
    v_and_b32 v23, v31, v5
    v_and_b32 v24, v31, v6
    v_and_b32 v25, v31, v7
    s_nop 1
    v_mfma_f32_16x16x32_bf16 v[8:11], v[100:103], v[22:25], v[8:11]
    v_perm_b32 v30, v213, v213, s34
    v_and_b32 v18, v30, v4
    v_and_b32 v19, v30, v5
    v_and_b32 v20, v30, v6
    v_and_b32 v21, v30, v7
    s_nop 1
    v_mfma_f32_16x16x32_bf16 v[14:17], v[104:107], v[18:21], v[14:17]
    v_perm_b32 v31, v213, v213, s35
    v_and_b32 v22, v31, v4
    v_and_b32 v23, v31, v5
    v_and_b32 v24, v31, v6
    v_and_b32 v25, v31, v7
    s_nop 1
    v_mfma_f32_16x16x32_bf16 v[8:11], v[108:111], v[22:25], v[8:11]
    s_waitcnt vmcnt(18)
    v_perm_b32 v30, v214, v214, s34
    v_and_b32 v18, v30, v4
    v_and_b32 v19, v30, v5
    v_and_b32 v20, v30, v6
    v_and_b32 v21, v30, v7
    s_nop 1
    v_mfma_f32_16x16x32_bf16 v[14:17], v[112:115], v[18:21], v[14:17]
    v_perm_b32 v31, v214, v214, s35
    v_and_b32 v22, v31, v4
    v_and_b32 v23, v31, v5
    v_and_b32 v24, v31, v6
    v_and_b32 v25, v31, v7
    s_nop 1
    v_mfma_f32_16x16x32_bf16 v[8:11], v[116:119], v[22:25], v[8:11]
    v_perm_b32 v30, v215, v215, s34
    v_and_b32 v18, v30, v4
    v_and_b32 v19, v30, v5
    v_and_b32 v20, v30, v6
    v_and_b32 v21, v30, v7
    s_nop 1
    v_mfma_f32_16x16x32_bf16 v[14:17], v[120:123], v[18:21], v[14:17]
    v_perm_b32 v31, v215, v215, s35
    v_and_b32 v22, v31, v4
    v_and_b32 v23, v31, v5
    v_and_b32 v24, v31, v6
    v_and_b32 v25, v31, v7
    s_nop 1
    v_mfma_f32_16x16x32_bf16 v[8:11], v[124:127], v[22:25], v[8:11]
    v_perm_b32 v30, v216, v216, s34
    v_and_b32 v18, v30, v4
    v_and_b32 v19, v30, v5
    v_and_b32 v20, v30, v6
    v_and_b32 v21, v30, v7
    s_nop 1
    v_mfma_f32_16x16x32_bf16 v[14:17], v[128:131], v[18:21], v[14:17]
    v_perm_b32 v31, v216, v216, s35
    v_and_b32 v22, v31, v4
    v_and_b32 v23, v31, v5
    v_and_b32 v24, v31, v6
    v_and_b32 v25, v31, v7
    s_nop 1
    v_mfma_f32_16x16x32_bf16 v[8:11], v[132:135], v[22:25], v[8:11]
    s_waitcnt vmcnt(12)
    v_perm_b32 v30, v217, v217, s34
    v_and_b32 v18, v30, v4
    v_and_b32 v19, v30, v5
    v_and_b32 v20, v30, v6
    v_and_b32 v21, v30, v7
    s_nop 1
    v_mfma_f32_16x16x32_bf16 v[14:17], v[136:139], v[18:21], v[14:17]
    v_perm_b32 v31, v217, v217, s35
    v_and_b32 v22, v31, v4
    v_and_b32 v23, v31, v5
    v_and_b32 v24, v31, v6
    v_and_b32 v25, v31, v7
    s_nop 1
    v_mfma_f32_16x16x32_bf16 v[8:11], v[140:143], v[22:25], v[8:11]
    v_perm_b32 v30, v218, v218, s34
    v_and_b32 v18, v30, v4
    v_and_b32 v19, v30, v5
    v_and_b32 v20, v30, v6
    v_and_b32 v21, v30, v7
    s_nop 1
    v_mfma_f32_16x16x32_bf16 v[14:17], v[144:147], v[18:21], v[14:17]
    v_perm_b32 v31, v218, v218, s35
    v_and_b32 v22, v31, v4
    v_and_b32 v23, v31, v5
    v_and_b32 v24, v31, v6
    v_and_b32 v25, v31, v7
    s_nop 1
    v_mfma_f32_16x16x32_bf16 v[8:11], v[148:151], v[22:25], v[8:11]
    v_perm_b32 v30, v219, v219, s34
    v_and_b32 v18, v30, v4
    v_and_b32 v19, v30, v5
    v_and_b32 v20, v30, v6
    v_and_b32 v21, v30, v7
    s_nop 1
    v_mfma_f32_16x16x32_bf16 v[14:17], v[152:155], v[18:21], v[14:17]
    v_perm_b32 v31, v219, v219, s35
    v_and_b32 v22, v31, v4
    v_and_b32 v23, v31, v5
    v_and_b32 v24, v31, v6
    v_and_b32 v25, v31, v7
    s_nop 1
    v_mfma_f32_16x16x32_bf16 v[8:11], v[156:159], v[22:25], v[8:11]
    s_waitcnt vmcnt(6)
    v_perm_b32 v30, v220, v220, s34
    v_and_b32 v18, v30, v4
    v_and_b32 v19, v30, v5
    v_and_b32 v20, v30, v6
    v_and_b32 v21, v30, v7
    s_nop 1
    v_mfma_f32_16x16x32_bf16 v[14:17], v[160:163], v[18:21], v[14:17]
    v_perm_b32 v31, v220, v220, s35
    v_and_b32 v22, v31, v4
    v_and_b32 v23, v31, v5
    v_and_b32 v24, v31, v6
    v_and_b32 v25, v31, v7
    s_nop 1
    v_mfma_f32_16x16x32_bf16 v[8:11], v[164:167], v[22:25], v[8:11]
    v_perm_b32 v30, v221, v221, s34
    v_and_b32 v18, v30, v4
    v_and_b32 v19, v30, v5
    v_and_b32 v20, v30, v6
    v_and_b32 v21, v30, v7
    s_nop 1
    v_mfma_f32_16x16x32_bf16 v[14:17], v[168:171], v[18:21], v[14:17]
    v_perm_b32 v31, v221, v221, s35
    v_and_b32 v22, v31, v4
    v_and_b32 v23, v31, v5
    v_and_b32 v24, v31, v6
    v_and_b32 v25, v31, v7
    s_nop 1
    v_mfma_f32_16x16x32_bf16 v[8:11], v[172:175], v[22:25], v[8:11]
    v_perm_b32 v30, v222, v222, s34
    v_and_b32 v18, v30, v4
    v_and_b32 v19, v30, v5
    v_and_b32 v20, v30, v6
    v_and_b32 v21, v30, v7
    s_nop 1
    v_mfma_f32_16x16x32_bf16 v[14:17], v[176:179], v[18:21], v[14:17]
    v_perm_b32 v31, v222, v222, s35
    v_and_b32 v22, v31, v4
    v_and_b32 v23, v31, v5
    v_and_b32 v24, v31, v6
    v_and_b32 v25, v31, v7
    s_nop 1
    v_mfma_f32_16x16x32_bf16 v[8:11], v[180:183], v[22:25], v[8:11]
    s_waitcnt vmcnt(0)
    v_perm_b32 v30, v223, v223, s34
    v_and_b32 v18, v30, v4
    v_and_b32 v19, v30, v5
    v_and_b32 v20, v30, v6
    v_and_b32 v21, v30, v7
    s_nop 1
    v_mfma_f32_16x16x32_bf16 v[14:17], v[184:187], v[18:21], v[14:17]
    v_perm_b32 v31, v223, v223, s35
    v_and_b32 v22, v31, v4
    v_and_b32 v23, v31, v5
    v_and_b32 v24, v31, v6
    v_and_b32 v25, v31, v7
    s_nop 1
    v_mfma_f32_16x16x32_bf16 v[8:11], v[188:191], v[22:25], v[8:11]
    v_perm_b32 v30, v224, v224, s34
    v_and_b32 v18, v30, v4
    v_and_b32 v19, v30, v5
    v_and_b32 v20, v30, v6
    v_and_b32 v21, v30, v7
    s_nop 1
    v_mfma_f32_16x16x32_bf16 v[14:17], v[192:195], v[18:21], v[14:17]
    v_perm_b32 v31, v224, v224, s35
    v_and_b32 v22, v31, v4
    v_and_b32 v23, v31, v5
    v_and_b32 v24, v31, v6
    v_and_b32 v25, v31, v7
    s_nop 1
    v_mfma_f32_16x16x32_bf16 v[8:11], v[196:199], v[22:25], v[8:11]
    v_perm_b32 v30, v225, v225, s34
    v_and_b32 v18, v30, v4
    v_and_b32 v19, v30, v5
    v_and_b32 v20, v30, v6
    v_and_b32 v21, v30, v7
    s_nop 1
    v_mfma_f32_16x16x32_bf16 v[14:17], v[200:203], v[18:21], v[14:17]
    v_perm_b32 v31, v225, v225, s35
    v_and_b32 v22, v31, v4
    v_and_b32 v23, v31, v5
    v_and_b32 v24, v31, v6
    v_and_b32 v25, v31, v7
    s_nop 1
    v_mfma_f32_16x16x32_bf16 v[8:11], v[204:207], v[22:25], v[8:11]
    s_lshl_b32 s62, s2, 10
    s_add_u32 s62, s62, 4096
    s_nop 7
    v_add_f32 v14, v14, v8
    v_add_f32 v15, v15, v9
    v_add_f32 v16, v16, v10
    v_add_f32 v17, v17, v11
    v_bfi_b32 v14, v63, s70, v14
    v_bfi_b32 v15, v63, s71, v15
    v_bfi_b32 v16, v63, s72, v16
    v_bfi_b32 v17, v63, s73, v17
    buffer_store_dwordx4 v[14:17], v52, s[24:27], s62 offen sc1
    s_and_b32 s65, s2, 7
    s_cmp_lg_u32 s65, 0
    s_cbranch_scc1 L_noinit
    s_lshr_b32 s65, s2, 3
    v_mov_b32 v26, s65
    s_lshl_b32 s65, s65, 1
    s_add_u32 s65, s65, 31
    v_add_u32 v27, s65, v1
    v_cmp_eq_u32 vcc, 0, v1
    s_lshl_b32 s65, s78, 10
    s_nop 0
    v_cndmask_b32 v26, v27, v26, vcc
    v_lshlrev_b32 v26, 7, v26
    v_mov_b32 v27, s65
    s_mov_b32 s65, 327680
    s_mov_b64 exec, 7
    buffer_store_dword v27, v26, s[24:27], s65 offen sc1
    s_mov_b64 exec, -1
L_noinit:
    s_mov_b32 s92, 20000
L_poll_q:
    buffer_load_dwordx4 v[224:227], v50, s[24:27], s80 offen offset:0 sc1
    buffer_load_dwordx4 v[228:231], v50, s[24:27], s80 offen offset:2048 sc1
    buffer_load_dwordx4 v[232:235], v50, s[24:27], s81 offen offset:0 sc1
    buffer_load_dwordx4 v[236:239], v50, s[24:27], s81 offen offset:2048 sc1
    buffer_load_dwordx4 v[240:243], v50, s[24:27], s82 offen offset:0 sc1
    buffer_load_dwordx4 v[244:247], v50, s[24:27], s82 offen offset:2048 sc1
    buffer_load_dwordx4 v[248:251], v50, s[24:27], s83 offen offset:0 sc1
    buffer_load_dwordx4 v[252:255], v50, s[24:27], s83 offen offset:2048 sc1
    s_waitcnt vmcnt(0)
    v_xor_b32 v26, s70, v224
    v_xor_b32 v27, s71, v225
    v_or_b32 v28, v26, v27
    v_xor_b32 v26, s72, v226
    v_xor_b32 v27, s73, v227
    v_or3_b32 v28, v26, v27, v28
    v_xor_b32 v26, s70, v228
    v_xor_b32 v27, s71, v229
    v_or3_b32 v28, v26, v27, v28
    v_xor_b32 v26, s72, v230
    v_xor_b32 v27, s73, v231
    v_or3_b32 v28, v26, v27, v28
    v_xor_b32 v26, s70, v232
    v_xor_b32 v27, s71, v233
    v_or3_b32 v28, v26, v27, v28
    v_xor_b32 v26, s72, v234
    v_xor_b32 v27, s73, v235
    v_or3_b32 v28, v26, v27, v28
    v_xor_b32 v26, s70, v236
    v_xor_b32 v27, s71, v237
    v_or3_b32 v28, v26, v27, v28
    v_xor_b32 v26, s72, v238
    v_xor_b32 v27, s73, v239
    v_or3_b32 v28, v26, v27, v28
    v_xor_b32 v26, s70, v240
    v_xor_b32 v27, s71, v241
    v_or3_b32 v28, v26, v27, v28
    v_xor_b32 v26, s72, v242
    v_xor_b32 v27, s73, v243
    v_or3_b32 v28, v26, v27, v28
    v_xor_b32 v26, s70, v244
    v_xor_b32 v27, s71, v245
    v_or3_b32 v28, v26, v27, v28
    v_xor_b32 v26, s72, v246
    v_xor_b32 v27, s73, v247
    v_or3_b32 v28, v26, v27, v28
    v_xor_b32 v26, s70, v248
    v_xor_b32 v27, s71, v249
    v_or3_b32 v28, v26, v27, v28
    v_xor_b32 v26, s72, v250
    v_xor_b32 v27, s73, v251
    v_or3_b32 v28, v26, v27, v28
    v_xor_b32 v26, s70, v252
    v_xor_b32 v27, s71, v253
    v_or3_b32 v28, v26, v27, v28
    v_xor_b32 v26, s72, v254
    v_xor_b32 v27, s73, v255
    v_or3_b32 v28, v26, v27, v28
    v_and_b32 v28, v63, v28
    v_cmp_ne_u32 vcc, 0, v28
    s_nop 1
    s_cmp_eq_u64 vcc, 0
    s_cbranch_scc1 L_polld_q
    s_sleep 1
    s_sub_u32 s92, s92, 1
    s_cmp_lg_u32 s92, 0
    s_cbranch_scc1 L_poll_q
L_polld_q:
    v_add_f32 v224, v224, v228
    v_add_f32 v225, v225, v229
    v_add_f32 v226, v226, v230
    v_add_f32 v227, v227, v231
    v_mov_b32 v228, v224
    v_mov_b32 v229, v225
    v_mov_b32 v230, v226
    v_mov_b32 v231, v227
    v_add_f32 v232, v232, v236
    v_add_f32 v233, v233, v237
    v_add_f32 v234, v234, v238
    v_add_f32 v235, v235, v239
    v_mov_b32 v236, v232
    v_mov_b32 v237, v233
    v_mov_b32 v238, v234
    v_mov_b32 v239, v235
    v_add_f32 v240, v240, v244
    v_add_f32 v241, v241, v245
    v_add_f32 v242, v242, v246
    v_add_f32 v243, v243, v247
    v_mov_b32 v244, v240
    v_mov_b32 v245, v241
    v_mov_b32 v246, v242
    v_mov_b32 v247, v243
    v_add_f32 v248, v248, v252
    v_add_f32 v249, v249, v253
    v_add_f32 v250, v250, v254
    v_add_f32 v251, v251, v255
    v_mov_b32 v252, v248
    v_mov_b32 v253, v249
    v_mov_b32 v254, v250
    v_mov_b32 v255, v251
    s_nop 0
    v_permlane32_swap_b32 v224, v228
    v_permlane32_swap_b32 v225, v229
    v_permlane32_swap_b32 v226, v230
    v_permlane32_swap_b32 v227, v231
    v_permlane32_swap_b32 v232, v236
    v_permlane32_swap_b32 v233, v237
    v_permlane32_swap_b32 v234, v238
    v_permlane32_swap_b32 v235, v239
    v_permlane32_swap_b32 v240, v244
    v_permlane32_swap_b32 v241, v245
    v_permlane32_swap_b32 v242, v246
    v_permlane32_swap_b32 v243, v247
    v_permlane32_swap_b32 v248, v252
    v_permlane32_swap_b32 v249, v253
    v_permlane32_swap_b32 v250, v254
    v_permlane32_swap_b32 v251, v255
    s_nop 0
    v_add_f32 v224, v224, v228
    v_add_f32 v225, v225, v229
    v_add_f32 v226, v226, v230
    v_add_f32 v227, v227, v231
    v_cvt_pk_bf16_f32 v224, v224, v225
    v_cvt_pk_bf16_f32 v226, v226, v227
    ds_write_b16 v51, v224 offset:0
    ds_write_b16_d16_hi v51, v224 offset:16
    ds_write_b16 v51, v226 offset:32
    ds_write_b16_d16_hi v51, v226 offset:48
    v_add_f32 v232, v232, v236
    v_add_f32 v233, v233, v237
    v_add_f32 v234, v234, v238
    v_add_f32 v235, v235, v239
    v_cvt_pk_bf16_f32 v232, v232, v233
    v_cvt_pk_bf16_f32 v234, v234, v235
    ds_write_b16 v51, v232 offset:256
    ds_write_b16_d16_hi v51, v232 offset:272
    ds_write_b16 v51, v234 offset:288
    ds_write_b16_d16_hi v51, v234 offset:304
    v_add_f32 v240, v240, v244
    v_add_f32 v241, v241, v245
    v_add_f32 v242, v242, v246
    v_add_f32 v243, v243, v247
    v_cvt_pk_bf16_f32 v240, v240, v241
    v_cvt_pk_bf16_f32 v242, v242, v243
    ds_write_b16 v51, v240 offset:512
    ds_write_b16_d16_hi v51, v240 offset:528
    ds_write_b16 v51, v242 offset:544
    ds_write_b16_d16_hi v51, v242 offset:560
    v_add_f32 v248, v248, v252
    v_add_f32 v249, v249, v253
    v_add_f32 v250, v250, v254
    v_add_f32 v251, v251, v255
    v_cvt_pk_bf16_f32 v248, v248, v249
    v_cvt_pk_bf16_f32 v250, v250, v251
    ds_write_b16 v51, v248 offset:768
    ds_write_b16_d16_hi v51, v248 offset:784
    ds_write_b16 v51, v250 offset:800
    ds_write_b16_d16_hi v51, v250 offset:816
    v_mov_b32 v26, 0
    ds_write_b32 v26, v26 offset:1536
    s_waitcnt lgkmcnt(0)
    s_barrier
    s_and_b32 s62, s2, 127
    s_lshl_b32 s62, s62, 5
    v_lshlrev_b32 v26, 3, v3
    v_add_u32 v26, s62, v26
    v_mul_u32_u24 v26, 1152, v26
    v_lshl_add_u32 v59, v2, 3, v26
    v_lshl_add_u32 v58, v2, 4, v26
    v_lshrrev_b32 v28, 5, v1
    v_mul_u32_u24 v53, 163840, v28
    v_bfe_u32 v29, v1, 3, 2
    v_mul_u32_u24 v29, 640, v29
    v_add_u32 v60, v53, v29
    v_and_b32 v30, 7, v1
    v_lshl_add_u32 v54, v30, 4, v60
    s_lshr_b32 s62, s2, 7
    s_lshl_b32 s62, s62, 6
    s_add_u32 s62, s62, s63
    s_mul_i32 s62, s62, 5120
    s_add_u32 s80, s62, 1048576
    s_add_u32 s81, s80, 2560
    s_lshl_b32 s65, s64, 7
    s_add_u32 s82, s80, s65
    s_add_u32 s83, s81, s65
    v_lshlrev_b32 v55, 7, v28
    v_lshl_add_u32 v55, v30, 2, v55
    v_lshrrev_b32 v56, 3, v2
    v_lshlrev_b32 v56, 7, v56
    v_lshl_add_u32 v56, v3, 5, v56
    v_lshrrev_b32 v26, 3, v2
    v_lshlrev_b32 v26, 2, v26
    v_lshl_add_u32 v26, v3, 3, v26
    v_and_b32 v27, 3, v2
    v_add_u32 v26, v26, v27
    v_lshlrev_b32 v61, 4, v26
    v_lshrrev_b32 v28, 2, v1
    v_mul_u32_u24 v28, 4608, v28
    v_lshl_add_u32 v57, v27, 4, v28
    s_mul_i32 s84, s2, 4608
    s_add_u32 s84, s84, 2097152
    s_add_u32 s85, s84, 4096
    v_mov_b32 v26, 0
    s_mov_b32 s92, 1000000
L_wfl:
    s_sleep 4
    ds_read_b32 v27, v26 offset:1536
    s_waitcnt lgkmcnt(0)
    v_readfirstlane_b32 s30, v27
    s_sub_u32 s92, s92, 1
    s_cmp_eq_u32 s92, 0
    s_cbranch_scc1 L_wfl2
    s_cmp_eq_u32 s30, 0
    s_cbranch_scc1 L_wfl
L_wfl2:
    s_mov_b32 s30, 0
    buffer_load_dwordx4 v[64:67], v58, s[4:7], s30 offen offset:0 nt
    buffer_load_dwordx4 v[68:71], v58, s[4:7], s30 offen offset:256 nt
    buffer_load_dwordx4 v[72:75], v58, s[4:7], s30 offen offset:512 nt
    buffer_load_dwordx4 v[76:79], v58, s[4:7], s30 offen offset:768 nt
    buffer_load_dwordx2 v[80:81], v59, s[4:7], s30 offen offset:1024 nt
    s_mov_b32 s30, 1152
    buffer_load_dwordx4 v[82:85], v58, s[4:7], s30 offen offset:0 nt
    buffer_load_dwordx4 v[86:89], v58, s[4:7], s30 offen offset:256 nt
    buffer_load_dwordx4 v[90:93], v58, s[4:7], s30 offen offset:512 nt
    buffer_load_dwordx4 v[94:97], v58, s[4:7], s30 offen offset:768 nt
    buffer_load_dwordx2 v[98:99], v59, s[4:7], s30 offen offset:1024 nt
    s_mov_b32 s30, 2304
    buffer_load_dwordx4 v[100:103], v58, s[4:7], s30 offen offset:0 nt
    buffer_load_dwordx4 v[104:107], v58, s[4:7], s30 offen offset:256 nt
    buffer_load_dwordx4 v[108:111], v58, s[4:7], s30 offen offset:512 nt
    buffer_load_dwordx4 v[112:115], v58, s[4:7], s30 offen offset:768 nt
    buffer_load_dwordx2 v[116:117], v59, s[4:7], s30 offen offset:1024 nt
    s_mov_b32 s30, 3456
    buffer_load_dwordx4 v[118:121], v58, s[4:7], s30 offen offset:0 nt
    buffer_load_dwordx4 v[122:125], v58, s[4:7], s30 offen offset:256 nt
    buffer_load_dwordx4 v[126:129], v58, s[4:7], s30 offen offset:512 nt
    buffer_load_dwordx4 v[130:133], v58, s[4:7], s30 offen offset:768 nt
    buffer_load_dwordx2 v[134:135], v59, s[4:7], s30 offen offset:1024 nt
    s_mov_b32 s30, 4608
    buffer_load_dwordx4 v[136:139], v58, s[4:7], s30 offen offset:0 nt
    buffer_load_dwordx4 v[140:143], v58, s[4:7], s30 offen offset:256 nt
    buffer_load_dwordx4 v[144:147], v58, s[4:7], s30 offen offset:512 nt
    buffer_load_dwordx4 v[148:151], v58, s[4:7], s30 offen offset:768 nt
    buffer_load_dwordx2 v[152:153], v59, s[4:7], s30 offen offset:1024 nt
    s_mov_b32 s30, 5760
    buffer_load_dwordx4 v[154:157], v58, s[4:7], s30 offen offset:0 nt
    buffer_load_dwordx4 v[158:161], v58, s[4:7], s30 offen offset:256 nt
    buffer_load_dwordx4 v[162:165], v58, s[4:7], s30 offen offset:512 nt
    buffer_load_dwordx4 v[166:169], v58, s[4:7], s30 offen offset:768 nt
    buffer_load_dwordx2 v[170:171], v59, s[4:7], s30 offen offset:1024 nt
    s_mov_b32 s30, 6912
    buffer_load_dwordx4 v[172:175], v58, s[4:7], s30 offen offset:0 nt
    buffer_load_dwordx4 v[176:179], v58, s[4:7], s30 offen offset:256 nt
    buffer_load_dwordx4 v[180:183], v58, s[4:7], s30 offen offset:512 nt
    buffer_load_dwordx4 v[184:187], v58, s[4:7], s30 offen offset:768 nt
    buffer_load_dwordx2 v[188:189], v59, s[4:7], s30 offen offset:1024 nt
    s_mov_b32 s30, 8064
    buffer_load_dwordx4 v[190:193], v58, s[4:7], s30 offen offset:0 nt
    buffer_load_dwordx4 v[194:197], v58, s[4:7], s30 offen offset:256 nt
    buffer_load_dwordx4 v[198:201], v58, s[4:7], s30 offen offset:512 nt
    buffer_load_dwordx4 v[202:205], v58, s[4:7], s30 offen offset:768 nt
    buffer_load_dwordx2 v[206:207], v59, s[4:7], s30 offen offset:1024 nt
    s_barrier
    s_mov_b32 s92, 20000
L_poll_o:
    buffer_load_dwordx4 v[240:243], v54, s[24:27], s82 offen sc1
    buffer_load_dwordx4 v[244:247], v54, s[24:27], s83 offen sc1
    buffer_load_dwordx4 v[248:251], v60, s[24:27], s80 offen offset:512 sc1
    buffer_load_dwordx4 v[252:255], v60, s[24:27], s81 offen offset:512 sc1
    buffer_load_dwordx4 v[208:211], v53, s[24:27], s80 offen offset:512 sc1
    buffer_load_dwordx4 v[212:215], v53, s[24:27], s80 offen offset:1152 sc1
    buffer_load_dwordx4 v[216:219], v53, s[24:27], s80 offen offset:1792 sc1
    buffer_load_dwordx4 v[220:223], v53, s[24:27], s80 offen offset:2432 sc1
    buffer_load_dwordx4 v[224:227], v53, s[24:27], s81 offen offset:512 sc1
    buffer_load_dwordx4 v[228:231], v53, s[24:27], s81 offen offset:1152 sc1
    buffer_load_dwordx4 v[232:235], v53, s[24:27], s81 offen offset:1792 sc1
    buffer_load_dwordx4 v[236:239], v53, s[24:27], s81 offen offset:2432 sc1
    s_waitcnt vmcnt(0)
    v_xor_b32 v26, s70, v240
    v_xor_b32 v27, s71, v241
    v_or_b32 v28, v26, v27
    v_xor_b32 v26, s72, v242
    v_xor_b32 v27, s73, v243
    v_or3_b32 v28, v26, v27, v28
    v_xor_b32 v26, s70, v244
    v_xor_b32 v27, s71, v245
    v_or3_b32 v28, v26, v27, v28
    v_xor_b32 v26, s72, v246
    v_xor_b32 v27, s73, v247
    v_or3_b32 v28, v26, v27, v28
    v_xor_b32 v26, s70, v248
    v_xor_b32 v27, s71, v249
    v_or3_b32 v28, v26, v27, v28
    v_xor_b32 v26, s72, v250
    v_xor_b32 v27, s73, v251
    v_or3_b32 v28, v26, v27, v28
    v_xor_b32 v26, s70, v252
    v_xor_b32 v27, s71, v253
    v_or3_b32 v28, v26, v27, v28
    v_xor_b32 v26, s72, v254
    v_xor_b32 v27, s73, v255
    v_or3_b32 v28, v26, v27, v28
    v_xor_b32 v26, s70, v208
    v_xor_b32 v27, s71, v209
    v_or3_b32 v28, v26, v27, v28
    v_xor_b32 v26, s72, v210
    v_xor_b32 v27, s73, v211
    v_or3_b32 v28, v26, v27, v28
    v_xor_b32 v26, s70, v212
    v_xor_b32 v27, s71, v213
    v_or3_b32 v28, v26, v27, v28
    v_xor_b32 v26, s72, v214
    v_xor_b32 v27, s73, v215
    v_or3_b32 v28, v26, v27, v28
    v_xor_b32 v26, s70, v216
    v_xor_b32 v27, s71, v217
    v_or3_b32 v28, v26, v27, v28
    v_xor_b32 v26, s72, v218
    v_xor_b32 v27, s73, v219
    v_or3_b32 v28, v26, v27, v28
    v_xor_b32 v26, s70, v220
    v_xor_b32 v27, s71, v221
    v_or3_b32 v28, v26, v27, v28
    v_xor_b32 v26, s72, v222
    v_xor_b32 v27, s73, v223
    v_or3_b32 v28, v26, v27, v28
    v_xor_b32 v26, s70, v224
    v_xor_b32 v27, s71, v225
    v_or3_b32 v28, v26, v27, v28
    v_xor_b32 v26, s72, v226
    v_xor_b32 v27, s73, v227
    v_or3_b32 v28, v26, v27, v28
    v_xor_b32 v26, s70, v228
    v_xor_b32 v27, s71, v229
    v_or3_b32 v28, v26, v27, v28
    v_xor_b32 v26, s72, v230
    v_xor_b32 v27, s73, v231
    v_or3_b32 v28, v26, v27, v28
    v_xor_b32 v26, s70, v232
    v_xor_b32 v27, s71, v233
    v_or3_b32 v28, v26, v27, v28
    v_xor_b32 v26, s72, v234
    v_xor_b32 v27, s73, v235
    v_or3_b32 v28, v26, v27, v28
    v_xor_b32 v26, s70, v236
    v_xor_b32 v27, s71, v237
    v_or3_b32 v28, v26, v27, v28
    v_xor_b32 v26, s72, v238
    v_xor_b32 v27, s73, v239
    v_or3_b32 v28, v26, v27, v28
    v_and_b32 v28, v63, v28
    v_cmp_ne_u32 vcc, 0, v28
    s_nop 1
    s_cmp_eq_u64 vcc, 0
    s_cbranch_scc1 L_polld_o
    s_sleep 1
    s_sub_u32 s92, s92, 1
    s_cmp_lg_u32 s92, 0
    s_cbranch_scc1 L_poll_o
L_polld_o:
    v_max3_f32 v14, v208, v212, v216
    v_max3_f32 v14, v14, v220, v224
    v_max3_f32 v14, v14, v228, v232
    v_max_f32 v14, v14, v236
    v_sub_f32 v248, v248, v14
    v_sub_f32 v252, v252, v14
    v_sub_f32 v208, v208, v14
    v_sub_f32 v212, v212, v14
    v_sub_f32 v216, v216, v14
    v_sub_f32 v220, v220, v14
    v_sub_f32 v224, v224, v14
    v_sub_f32 v228, v228, v14
    v_sub_f32 v232, v232, v14
    v_sub_f32 v236, v236, v14
    v_exp_f32 v248, v248
    v_exp_f32 v252, v252
    v_exp_f32 v208, v208
    v_exp_f32 v212, v212
    v_exp_f32 v216, v216
    v_exp_f32 v220, v220
    v_exp_f32 v224, v224
    v_exp_f32 v228, v228
    v_exp_f32 v232, v232
    v_exp_f32 v236, v236
    v_mul_f32 v240, v248, v240
    v_mul_f32 v241, v248, v241
    v_mul_f32 v242, v248, v242
    v_mul_f32 v243, v248, v243
    v_fma_f32 v240, v252, v244, v240
    v_fma_f32 v241, v252, v245, v241
    v_fma_f32 v242, v252, v246, v242
    v_fma_f32 v243, v252, v247, v243
    v_mul_f32 v15, v208, v209
    v_add_f32_dpp v240, v240, v240 row_ror:8 row_mask:0xf bank_mask:0xf
    v_add_f32_dpp v241, v241, v241 row_ror:8 row_mask:0xf bank_mask:0xf
    v_add_f32_dpp v242, v242, v242 row_ror:8 row_mask:0xf bank_mask:0xf
    v_add_f32_dpp v243, v243, v243 row_ror:8 row_mask:0xf bank_mask:0xf
    v_fma_f32 v15, v212, v213, v15
    v_fma_f32 v15, v216, v217, v15
    v_fma_f32 v15, v220, v221, v15
    v_fma_f32 v15, v224, v225, v15
    v_fma_f32 v15, v228, v229, v15
    v_fma_f32 v15, v232, v233, v15
    v_fma_f32 v15, v236, v237, v15
    v_mov_b32 v244, v240
    v_mov_b32 v245, v241
    v_mov_b32 v246, v242
    v_mov_b32 v247, v243
    v_rcp_f32 v15, v15
    s_nop 0
    v_permlane16_swap_b32 v240, v244
    v_permlane16_swap_b32 v241, v245
    v_permlane16_swap_b32 v242, v246
    v_permlane16_swap_b32 v243, v247
    s_nop 0
    v_add_f32 v240, v240, v244
    v_add_f32 v241, v241, v245
    v_add_f32 v242, v242, v246
    v_add_f32 v243, v243, v247
    v_mul_f32 v240, v15, v240
    v_mul_f32 v241, v15, v241
    v_mul_f32 v242, v15, v242
    v_mul_f32 v243, v15, v243
    ds_write_b32 v55, v240 offset:1024
    ds_write_b32 v55, v241 offset:1056
    ds_write_b32 v55, v242 offset:1088
    ds_write_b32 v55, v243 offset:1120
    s_waitcnt lgkmcnt(0)
    ds_read_b128 v[208:211], v56 offset:1024
    ds_read_b128 v[212:215], v56 offset:1040
    s_waitcnt lgkmcnt(1)
    v_cvt_pk_bf16_f32 v208, v208, v208
    v_and_b32 v216, v208, v4
    v_and_b32 v217, v208, v5
    v_and_b32 v218, v208, v6
    v_and_b32 v219, v208, v7
    v_cvt_pk_bf16_f32 v209, v209, v209
    v_and_b32 v220, v209, v4
    v_and_b32 v221, v209, v5
    v_and_b32 v222, v209, v6
    v_and_b32 v223, v209, v7
    v_mfma_f32_16x16x32_bf16 v[32:35], v[64:67], v[216:219], 0
    v_mfma_f32_16x16x32_bf16 v[36:39], v[68:71], v[216:219], 0
    v_mfma_f32_16x16x32_bf16 v[40:43], v[72:75], v[216:219], 0
    v_mfma_f32_16x16x32_bf16 v[44:47], v[76:79], v[216:219], 0
    v_mfma_f32_16x16x16_bf16 v[8:11], v[80:81], v[216:217], 0
    v_cvt_pk_bf16_f32 v210, v210, v210
    v_and_b32 v224, v210, v4
    v_and_b32 v225, v210, v5
    v_and_b32 v226, v210, v6
    v_and_b32 v227, v210, v7
    v_mfma_f32_16x16x32_bf16 v[32:35], v[82:85], v[220:223], v[32:35]
    v_mfma_f32_16x16x32_bf16 v[36:39], v[86:89], v[220:223], v[36:39]
    v_mfma_f32_16x16x32_bf16 v[40:43], v[90:93], v[220:223], v[40:43]
    v_mfma_f32_16x16x32_bf16 v[44:47], v[94:97], v[220:223], v[44:47]
    v_mfma_f32_16x16x16_bf16 v[8:11], v[98:99], v[220:221], v[8:11]
    v_cvt_pk_bf16_f32 v211, v211, v211
    v_and_b32 v228, v211, v4
    v_and_b32 v229, v211, v5
    v_and_b32 v230, v211, v6
    v_and_b32 v231, v211, v7
    v_mfma_f32_16x16x32_bf16 v[32:35], v[100:103], v[224:227], v[32:35]
    v_mfma_f32_16x16x32_bf16 v[36:39], v[104:107], v[224:227], v[36:39]
    v_mfma_f32_16x16x32_bf16 v[40:43], v[108:111], v[224:227], v[40:43]
    v_mfma_f32_16x16x32_bf16 v[44:47], v[112:115], v[224:227], v[44:47]
    v_mfma_f32_16x16x16_bf16 v[8:11], v[116:117], v[224:225], v[8:11]
    s_waitcnt lgkmcnt(0)
    v_cvt_pk_bf16_f32 v212, v212, v212
    v_and_b32 v232, v212, v4
    v_and_b32 v233, v212, v5
    v_and_b32 v234, v212, v6
    v_and_b32 v235, v212, v7
    v_mfma_f32_16x16x32_bf16 v[32:35], v[118:121], v[228:231], v[32:35]
    v_mfma_f32_16x16x32_bf16 v[36:39], v[122:125], v[228:231], v[36:39]
    v_mfma_f32_16x16x32_bf16 v[40:43], v[126:129], v[228:231], v[40:43]
    v_mfma_f32_16x16x32_bf16 v[44:47], v[130:133], v[228:231], v[44:47]
    v_mfma_f32_16x16x16_bf16 v[8:11], v[134:135], v[228:229], v[8:11]
    v_cvt_pk_bf16_f32 v213, v213, v213
    v_and_b32 v236, v213, v4
    v_and_b32 v237, v213, v5
    v_and_b32 v238, v213, v6
    v_and_b32 v239, v213, v7
    v_mfma_f32_16x16x32_bf16 v[32:35], v[136:139], v[232:235], v[32:35]
    v_mfma_f32_16x16x32_bf16 v[36:39], v[140:143], v[232:235], v[36:39]
    v_mfma_f32_16x16x32_bf16 v[40:43], v[144:147], v[232:235], v[40:43]
    v_mfma_f32_16x16x32_bf16 v[44:47], v[148:151], v[232:235], v[44:47]
    v_mfma_f32_16x16x16_bf16 v[8:11], v[152:153], v[232:233], v[8:11]
    v_cvt_pk_bf16_f32 v214, v214, v214
    v_and_b32 v240, v214, v4
    v_and_b32 v241, v214, v5
    v_and_b32 v242, v214, v6
    v_and_b32 v243, v214, v7
    v_mfma_f32_16x16x32_bf16 v[32:35], v[154:157], v[236:239], v[32:35]
    v_mfma_f32_16x16x32_bf16 v[36:39], v[158:161], v[236:239], v[36:39]
    v_mfma_f32_16x16x32_bf16 v[40:43], v[162:165], v[236:239], v[40:43]
    v_mfma_f32_16x16x32_bf16 v[44:47], v[166:169], v[236:239], v[44:47]
    v_mfma_f32_16x16x16_bf16 v[8:11], v[170:171], v[236:237], v[8:11]
    v_cvt_pk_bf16_f32 v215, v215, v215
    v_and_b32 v244, v215, v4
    v_and_b32 v245, v215, v5
    v_and_b32 v246, v215, v6
    v_and_b32 v247, v215, v7
    v_mfma_f32_16x16x32_bf16 v[32:35], v[172:175], v[240:243], v[32:35]
    v_mfma_f32_16x16x32_bf16 v[36:39], v[176:179], v[240:243], v[36:39]
    v_mfma_f32_16x16x32_bf16 v[40:43], v[180:183], v[240:243], v[40:43]
    v_mfma_f32_16x16x32_bf16 v[44:47], v[184:187], v[240:243], v[44:47]
    v_mfma_f32_16x16x16_bf16 v[8:11], v[188:189], v[240:241], v[8:11]
    v_mfma_f32_16x16x32_bf16 v[32:35], v[190:193], v[244:247], v[32:35]
    v_mfma_f32_16x16x32_bf16 v[36:39], v[194:197], v[244:247], v[36:39]
    v_mfma_f32_16x16x32_bf16 v[40:43], v[198:201], v[244:247], v[40:43]
    v_mfma_f32_16x16x32_bf16 v[44:47], v[202:205], v[244:247], v[44:47]
    v_mfma_f32_16x16x16_bf16 v[8:11], v[206:207], v[244:245], v[8:11]
    s_mov_b32 s74, 0x0f0f0f0f
    s_mov_b32 s75, 0x0f0f0f0f
    s_nop 2
    v_bfi_b32 v32, v63, s70, v32
    v_bfi_b32 v33, v63, s71, v33
    v_bfi_b32 v34, v63, s72, v34
    v_bfi_b32 v35, v63, s73, v35
    buffer_store_dwordx4 v[32:35], v52, s[24:27], s84 offen offset:0 sc1
    v_bfi_b32 v36, v63, s70, v36
    v_bfi_b32 v37, v63, s71, v37
    v_bfi_b32 v38, v63, s72, v38
    v_bfi_b32 v39, v63, s73, v39
    buffer_store_dwordx4 v[36:39], v52, s[24:27], s84 offen offset:1024 sc1
    v_bfi_b32 v40, v63, s70, v40
    v_bfi_b32 v41, v63, s71, v41
    v_bfi_b32 v42, v63, s72, v42
    v_bfi_b32 v43, v63, s73, v43
    buffer_store_dwordx4 v[40:43], v52, s[24:27], s84 offen offset:2048 sc1
    v_bfi_b32 v44, v63, s70, v44
    v_bfi_b32 v45, v63, s71, v45
    v_bfi_b32 v46, v63, s72, v46
    v_bfi_b32 v47, v63, s73, v47
    buffer_store_dwordx4 v[44:47], v52, s[24:27], s84 offen offset:3072 sc1
    v_bfi_b32 v8, v63, s70, v8
    v_bfi_b32 v9, v63, s71, v9
    v_bfi_b32 v10, v63, s72, v10
    v_bfi_b32 v11, v63, s73, v11
    s_mov_b64 exec, s[74:75]
    buffer_store_dwordx4 v[8:11], v61, s[24:27], s85 offen sc1
    s_mov_b64 exec, -1
    s_cmp_ge_u32 s2, 144
    s_cbranch_scc1 L_hend
    s_cmp_ge_u32 s2, 72
    s_cselect_b32 s63, 1, 0
    s_mul_i32 s64, s63, 72
    s_sub_u32 s64, s2, s64
    s_mul_i32 s62, s63, 589824
    s_lshl_b32 s65, s64, 6
    s_add_u32 s62, s62, s65
    s_add_u32 s80, s62, 2097152
    s_add_u32 s81, s80, 73728
    s_add_u32 s82, s80, 147456
    s_add_u32 s83, s80, 221184
    s_add_u32 s84, s80, 294912
    s_add_u32 s85, s80, 368640
    s_add_u32 s86, s80, 442368
    s_add_u32 s87, s80, 516096
    s_lshl_b32 s65, s64, 2
    v_and_b32 v50, 3, v1
    v_add_u32 v50, s65, v50
    s_cmp_ge_u32 s64, 64
    s_cbranch_scc1 L_o4
    v_lshrrev_b32 v51, 4, v50
    v_lshlrev_b32 v51, 5, v51
    v_and_b32 v53, 7, v50
    v_add_u32 v51, v51, v53
    v_bfe_u32 v53, v50, 3, 1
    s_mov_b32 s66, 16
    s_branch L_o5
L_o4:
    v_bfe_u32 v51, v50, 3, 2
    v_lshlrev_b32 v51, 4, v51
    v_and_b32 v53, 3, v50
    v_add_u32 v51, v51, v53
    v_add_u32 v51, 512, v51
    v_bfe_u32 v53, v50, 2, 1
    s_mov_b32 s66, 8
L_o5:
    v_mul_u32_u24 v53, 1152, v53
    v_add_u32 v51, v51, v53
    s_mul_i32 s65, s63, 576
    v_add_u32 v51, s65, v51
    v_lshlrev_b32 v51, 1, v51
    s_lshl_b32 s65, s66, 1
    s_add_u32 s62, s65, s66
    s_mov_b32 s92, 20000
L_poll_y:
    buffer_load_dwordx4 v[64:67], v57, s[24:27], s80 offen sc1
    buffer_load_dwordx4 v[68:71], v57, s[24:27], s81 offen sc1
    buffer_load_dwordx4 v[72:75], v57, s[24:27], s82 offen sc1
    buffer_load_dwordx4 v[76:79], v57, s[24:27], s83 offen sc1
    buffer_load_dwordx4 v[80:83], v57, s[24:27], s84 offen sc1
    buffer_load_dwordx4 v[84:87], v57, s[24:27], s85 offen sc1
    buffer_load_dwordx4 v[88:91], v57, s[24:27], s86 offen sc1
    buffer_load_dwordx4 v[92:95], v57, s[24:27], s87 offen sc1
    s_waitcnt vmcnt(0)
    v_xor_b32 v26, s70, v64
    v_xor_b32 v27, s71, v65
    v_or_b32 v28, v26, v27
    v_xor_b32 v26, s72, v66
    v_xor_b32 v27, s73, v67
    v_or3_b32 v28, v26, v27, v28
    v_xor_b32 v26, s70, v68
    v_xor_b32 v27, s71, v69
    v_or3_b32 v28, v26, v27, v28
    v_xor_b32 v26, s72, v70
    v_xor_b32 v27, s73, v71
    v_or3_b32 v28, v26, v27, v28
    v_xor_b32 v26, s70, v72
    v_xor_b32 v27, s71, v73
    v_or3_b32 v28, v26, v27, v28
    v_xor_b32 v26, s72, v74
    v_xor_b32 v27, s73, v75
    v_or3_b32 v28, v26, v27, v28
    v_xor_b32 v26, s70, v76
    v_xor_b32 v27, s71, v77
    v_or3_b32 v28, v26, v27, v28
    v_xor_b32 v26, s72, v78
    v_xor_b32 v27, s73, v79
    v_or3_b32 v28, v26, v27, v28
    v_xor_b32 v26, s70, v80
    v_xor_b32 v27, s71, v81
    v_or3_b32 v28, v26, v27, v28
    v_xor_b32 v26, s72, v82
    v_xor_b32 v27, s73, v83
    v_or3_b32 v28, v26, v27, v28
    v_xor_b32 v26, s70, v84
    v_xor_b32 v27, s71, v85
    v_or3_b32 v28, v26, v27, v28
    v_xor_b32 v26, s72, v86
    v_xor_b32 v27, s73, v87
    v_or3_b32 v28, v26, v27, v28
    v_xor_b32 v26, s70, v88
    v_xor_b32 v27, s71, v89
    v_or3_b32 v28, v26, v27, v28
    v_xor_b32 v26, s72, v90
    v_xor_b32 v27, s73, v91
    v_or3_b32 v28, v26, v27, v28
    v_xor_b32 v26, s70, v92
    v_xor_b32 v27, s71, v93
    v_or3_b32 v28, v26, v27, v28
    v_xor_b32 v26, s72, v94
    v_xor_b32 v27, s73, v95
    v_or3_b32 v28, v26, v27, v28
    v_and_b32 v28, v63, v28
    v_cmp_ne_u32 vcc, 0, v28
    s_nop 1
    s_cmp_eq_u64 vcc, 0
    s_cbranch_scc1 L_polld_y
    s_sleep 1
    s_sub_u32 s92, s92, 1
    s_cmp_lg_u32 s92, 0
    s_cbranch_scc1 L_poll_y
L_polld_y:
    v_add_f32 v64, v64, v68
    v_add_f32 v65, v65, v69
    v_add_f32 v66, v66, v70
    v_add_f32 v67, v67, v71
    v_add_f32 v72, v72, v76
    v_add_f32 v73, v73, v77
    v_add_f32 v74, v74, v78
    v_add_f32 v75, v75, v79
    v_add_f32 v80, v80, v84
    v_add_f32 v81, v81, v85
    v_add_f32 v82, v82, v86
    v_add_f32 v83, v83, v87
    v_add_f32 v88, v88, v92
    v_add_f32 v89, v89, v93
    v_add_f32 v90, v90, v94
    v_add_f32 v91, v91, v95
    v_add_f32 v64, v64, v72
    v_add_f32 v65, v65, v73
    v_add_f32 v66, v66, v74
    v_add_f32 v67, v67, v75
    v_add_f32 v80, v80, v88
    v_add_f32 v81, v81, v89
    v_add_f32 v82, v82, v90
    v_add_f32 v83, v83, v91
    v_add_f32 v64, v64, v80
    v_add_f32 v65, v65, v81
    v_add_f32 v66, v66, v82
    v_add_f32 v67, v67, v83
    s_nop 0
    v_add_f32_dpp v64, v64, v64 row_ror:4 row_mask:0xf bank_mask:0xf
    v_add_f32_dpp v65, v65, v65 row_ror:4 row_mask:0xf bank_mask:0xf
    v_add_f32_dpp v66, v66, v66 row_ror:4 row_mask:0xf bank_mask:0xf
    v_add_f32_dpp v67, v67, v67 row_ror:4 row_mask:0xf bank_mask:0xf
    s_nop 0
    v_add_f32_dpp v64, v64, v64 row_ror:8 row_mask:0xf bank_mask:0xf
    v_add_f32_dpp v65, v65, v65 row_ror:8 row_mask:0xf bank_mask:0xf
    v_add_f32_dpp v66, v66, v66 row_ror:8 row_mask:0xf bank_mask:0xf
    v_add_f32_dpp v67, v67, v67 row_ror:8 row_mask:0xf bank_mask:0xf
    v_mov_b32 v68, v64
    v_mov_b32 v69, v65
    v_mov_b32 v70, v66
    v_mov_b32 v71, v67
    s_nop 0
    v_permlane16_swap_b32 v64, v68
    v_permlane16_swap_b32 v65, v69
    v_permlane16_swap_b32 v66, v70
    v_permlane16_swap_b32 v67, v71
    s_nop 0
    v_add_f32 v64, v64, v68
    v_add_f32 v65, v65, v69
    v_add_f32 v66, v66, v70
    v_add_f32 v67, v67, v71
    v_mov_b32 v68, v64
    v_mov_b32 v69, v65
    v_mov_b32 v70, v66
    v_mov_b32 v71, v67
    s_nop 0
    v_permlane32_swap_b32 v64, v68
    v_permlane32_swap_b32 v65, v69
    v_permlane32_swap_b32 v66, v70
    v_permlane32_swap_b32 v67, v71
    s_nop 0
    v_add_f32 v64, v64, v68
    v_add_f32 v65, v65, v69
    v_add_f32 v66, v66, v70
    v_add_f32 v67, v67, v71
    v_cvt_pk_bf16_f32 v64, v64, v65
    v_cvt_pk_bf16_f32 v66, v66, v67
    s_mov_b64 exec, 0xf
    buffer_store_short v64, v51, s[20:23], 0 offen
    buffer_store_short_d16_hi v64, v51, s[20:23], s66 offen
    buffer_store_short v66, v51, s[20:23], s65 offen
    buffer_store_short_d16_hi v66, v51, s[20:23], s62 offen
    s_cmp_lg_u32 s2, 0
    s_cbranch_scc1 L_hend
    s_mov_b64 exec, 1
    v_mov_b32 v26, s31
    v_mov_b32 v27, 0
    buffer_store_dword v26, v27, s[24:27], 0 offen
L_hend:
    s_mov_b64 exec, -1
    s_endpgm
L_stream:
    s_mov_b32 s7, 0x00020000
    s_mov_b32 s11, 0x00020000
    s_mov_b32 s15, 0x00020000
    s_mov_b32 s19, 0x00020000
    s_mov_b32 s23, 0x00020000
    s_mov_b32 s27, 0x00020000
    s_mov_b32 s26, 33554432
    v_mov_b32 v63, 0xff
    s_mov_b32 s32, 0x3e0293ee
    s_mov_b32 s33, 0xff61b1e6
    s_mov_b32 s34, 0x01000100
    s_mov_b32 s35, 0x03020302
    v_lshlrev_b32 v49, 10, v3
    v_lshl_add_u32 v49, v2, 4, v49
    v_lshlrev_b32 v48, 8, v2
    v_lshl_add_u32 v48, v3, 4, v48
    s_lshr_b32 s62, s2, 3
    s_and_b32 s63, s2, 7
    s_waitcnt lgkmcnt(0)
    s_load_dword s31, s[60:61], 0
    s_mov_b32 s24, s60
    s_mov_b32 s25, s61
    s_cmp_eq_u32 s3, 0
    s_cbranch_scc0 L_strB
    s_mov_b32 s4, s38
    s_mov_b32 s5, s39
    s_mov_b32 s8, s40
    s_mov_b32 s9, s41
    s_mov_b32 s93, 0x4000000
    s_lshl_b32 s79, s62, 21
    s_lshl_b32 s69, s62, 7
    s_lshl_b32 s67, s62, 4
    s_add_u32 s67, s67, s63
    s_mov_b64 s[74:75], -1
    s_mov_b32 s80, 0x101
    s_mov_b32 s81, 0
    v_lshrrev_b32 v50, 3, v2
    v_lshlrev_b32 v51, 8, v50
    v_mul_u32_u24 v50, 5120, v50
    s_branch L_strC
L_strB:
    s_mov_b32 s4, s48
    s_mov_b32 s5, s49
    s_mov_b32 s8, s50
    s_mov_b32 s9, s51
    s_mov_b32 s93, 0x8000000
    s_lshl_b32 s62, s62, 1
    s_add_u32 s62, s62, s3
    s_sub_u32 s62, s62, 1
    s_lshl_b32 s79, s62, 21
    s_add_u32 s69, s62, 32
    s_lshl_b32 s69, s69, 7
    s_add_u32 s67, s62, 64
    s_lshl_b32 s67, s67, 3
    s_add_u32 s67, s67, s63
    s_mov_b32 s74, 0x00ff00ff
    s_mov_b32 s75, 0x00ff00ff
    s_mov_b64 s[80:81], 1
    v_mov_b32 v50, 0
    s_add_u32 s64, s3, 1
    s_lshl_b32 s64, s64, 8
    v_mov_b32 v51, s64
L_strC:
    s_add_u32 s69, s69, 327680
    s_lshl_b32 s28, s63, 12
    s_mov_b32 s68, 32768
    s_add_u32 s28, s28, s79
    v_mov_b32 v52, 0
    s_mov_b32 s6, s93
    s_mov_b32 s10, s93
    s_barrier
    buffer_load_dwordx4 v[64:67], v48, s[4:7], s28 offen offset:0 nt
    buffer_load_dwordx4 v[68:71], v48, s[4:7], s28 offen offset:64 nt
    buffer_load_dwordx4 v[72:75], v48, s[4:7], s28 offen offset:128 nt
    buffer_load_dwordx4 v[76:79], v48, s[4:7], s28 offen offset:192 nt
    buffer_load_dwordx4 v[80:83], v49, s[8:11], s28 offen offset:0 nt
    buffer_load_dwordx4 v[84:87], v49, s[8:11], s28 offen offset:256 nt
    buffer_load_dwordx4 v[88:91], v49, s[8:11], s28 offen offset:512 nt
    buffer_load_dwordx4 v[92:95], v49, s[8:11], s28 offen offset:768 nt
    s_add_u32 s28, s28, s68
    buffer_load_dwordx4 v[96:99], v48, s[4:7], s28 offen offset:0 nt
    buffer_load_dwordx4 v[100:103], v48, s[4:7], s28 offen offset:64 nt
    buffer_load_dwordx4 v[104:107], v48, s[4:7], s28 offen offset:128 nt
    buffer_load_dwordx4 v[108:111], v48, s[4:7], s28 offen offset:192 nt
    buffer_load_dwordx4 v[112:115], v49, s[8:11], s28 offen offset:0 nt
    buffer_load_dwordx4 v[116:119], v49, s[8:11], s28 offen offset:256 nt
    buffer_load_dwordx4 v[120:123], v49, s[8:11], s28 offen offset:512 nt
    buffer_load_dwordx4 v[124:127], v49, s[8:11], s28 offen offset:768 nt
    s_add_u32 s28, s28, s68
    buffer_load_dwordx4 v[128:131], v48, s[4:7], s28 offen offset:0 nt
    buffer_load_dwordx4 v[132:135], v48, s[4:7], s28 offen offset:64 nt
    buffer_load_dwordx4 v[136:139], v48, s[4:7], s28 offen offset:128 nt
    buffer_load_dwordx4 v[140:143], v48, s[4:7], s28 offen offset:192 nt
    buffer_load_dwordx4 v[144:147], v49, s[8:11], s28 offen offset:0 nt
    buffer_load_dwordx4 v[148:151], v49, s[8:11], s28 offen offset:256 nt
    buffer_load_dwordx4 v[152:155], v49, s[8:11], s28 offen offset:512 nt
    buffer_load_dwordx4 v[156:159], v49, s[8:11], s28 offen offset:768 nt
    s_add_u32 s28, s28, s68
    buffer_load_dwordx4 v[160:163], v48, s[4:7], s28 offen offset:0 nt
    buffer_load_dwordx4 v[164:167], v48, s[4:7], s28 offen offset:64 nt
    buffer_load_dwordx4 v[168:171], v48, s[4:7], s28 offen offset:128 nt
    buffer_load_dwordx4 v[172:175], v48, s[4:7], s28 offen offset:192 nt
    buffer_load_dwordx4 v[176:179], v49, s[8:11], s28 offen offset:0 nt
    buffer_load_dwordx4 v[180:183], v49, s[8:11], s28 offen offset:256 nt
    buffer_load_dwordx4 v[184:187], v49, s[8:11], s28 offen offset:512 nt
    buffer_load_dwordx4 v[188:191], v49, s[8:11], s28 offen offset:768 nt
    s_add_u32 s28, s28, s68
    buffer_load_dwordx4 v[192:195], v48, s[4:7], s28 offen offset:0 nt
    buffer_load_dwordx4 v[196:199], v48, s[4:7], s28 offen offset:64 nt
    buffer_load_dwordx4 v[200:203], v48, s[4:7], s28 offen offset:128 nt
    buffer_load_dwordx4 v[204:207], v48, s[4:7], s28 offen offset:192 nt
    buffer_load_dwordx4 v[208:211], v49, s[8:11], s28 offen offset:0 nt
    buffer_load_dwordx4 v[212:215], v49, s[8:11], s28 offen offset:256 nt
    buffer_load_dwordx4 v[216:219], v49, s[8:11], s28 offen offset:512 nt
    buffer_load_dwordx4 v[220:223], v49, s[8:11], s28 offen offset:768 nt
    s_add_u32 s28, s28, s68
    buffer_load_dwordx4 v[224:227], v48, s[4:7], s28 offen offset:0 nt
    buffer_load_dwordx4 v[228:231], v48, s[4:7], s28 offen offset:64 nt
    buffer_load_dwordx4 v[232:235], v48, s[4:7], s28 offen offset:128 nt
    buffer_load_dwordx4 v[236:239], v48, s[4:7], s28 offen offset:192 nt
    buffer_load_dwordx4 v[240:243], v49, s[8:11], s28 offen offset:0 nt
    buffer_load_dwordx4 v[244:247], v49, s[8:11], s28 offen offset:256 nt
    buffer_load_dwordx4 v[248:251], v49, s[8:11], s28 offen offset:512 nt
    buffer_load_dwordx4 v[252:255], v49, s[8:11], s28 offen offset:768 nt
    s_add_u32 s28, s28, s68
    v_and_b32 v30, 1, v2
    v_lshlrev_b32 v30, 4, v30
    v_mov_b32 v31, 0xffff
    v_lshlrev_b32 v31, v30, v31
    v_bfe_u32 v30, v2, 1, 2
    v_cmp_eq_u32 vcc, 0, v30
    s_nop 1
    v_cndmask_b32 v4, 0, v31, vcc
    v_cmp_eq_u32 vcc, 1, v30
    s_nop 1
    v_cndmask_b32 v5, 0, v31, vcc
    v_cmp_eq_u32 vcc, 2, v30
    s_nop 1
    v_cndmask_b32 v6, 0, v31, vcc
    v_cmp_eq_u32 vcc, 3, v30
    s_nop 1
    v_cndmask_b32 v7, 0, v31, vcc
    v_mov_b32 v8, 0
    v_mov_b32 v9, 0
    v_mov_b32 v10, 0
    v_mov_b32 v11, 0
    v_mov_b32 v12, s33
    v_mov_b32 v13, 0
    v_lshl_add_u32 v51, v3, 4, v51
    v_and_b32 v54, 7, v2
    v_lshl_add_u32 v54, v3, 3, v54
    v_lshl_add_u32 v54, v54, 4, v50
    s_mul_i32 s67, s67, 640
    s_add_u32 s67, s67, 1048576
    s_barrier
    ds_read_b128 v[32:35], v51 offset:0
    ds_read_b128 v[36:39], v51 offset:64
    ds_read_b128 v[40:43], v51 offset:128
    ds_read_b128 v[44:47], v51 offset:192
    s_waitcnt lgkmcnt(0)
    s_add_u32 s31, s31, 1
    s_mul_i32 s70, s31, 0x9e3779b1
    s_lshr_b32 s71, s70, 8
    s_lshr_b32 s72, s70, 16
    s_lshr_b32 s73, s70, 24
    s_and_b32 s78, s31, 0x3fffff
    s_waitcnt vmcnt(44)
    v_mfma_f32_16x16x32_bf16 v[14:17], v[64:67], v[32:35], 0
    v_mfma_f32_16x16x32_bf16 v[14:17], v[68:71], v[36:39], v[14:17]
    v_mfma_f32_16x16x32_bf16 v[14:17], v[72:75], v[40:43], v[14:17]
    v_mfma_f32_16x16x32_bf16 v[14:17], v[76:79], v[44:47], v[14:17]
    s_nop 7
    v_max3_f32 v26, v14, v15, v16
    v_max3_f32 v26, v26, v17, v12
    v_mov_b32 v27, v26
    s_nop 1
    v_permlane16_swap_b32 v26, v27
    s_nop 0
    v_max_f32 v26, v26, v27
    v_mov_b32 v27, v26
    s_nop 1
    v_permlane32_swap_b32 v26, v27
    s_nop 0
    v_max_f32 v26, v26, v27
    v_sub_f32 v27, v12, v26
    v_mul_f32 v27, s32, v27
    v_exp_f32 v27, v27
    v_mov_b32 v12, v26
    v_mul_f32 v26, s32, v26
    v_fma_f32 v14, v14, s32, -v26
    v_fma_f32 v15, v15, s32, -v26
    v_fma_f32 v16, v16, s32, -v26
    v_fma_f32 v17, v17, s32, -v26
    v_exp_f32 v14, v14
    v_exp_f32 v15, v15
    v_exp_f32 v16, v16
    v_exp_f32 v17, v17
    v_mul_f32 v8, v27, v8
    v_mul_f32 v9, v27, v9
    v_mul_f32 v10, v27, v10
    v_mul_f32 v11, v27, v11
    v_add_f32 v28, v14, v15
    v_add_f32 v29, v16, v17
    v_fma_f32 v13, v13, v27, v28
    v_add_f32 v13, v13, v29
    v_cvt_pk_bf16_f32 v14, v14, v14
    v_cvt_pk_bf16_f32 v15, v15, v15
    v_cvt_pk_bf16_f32 v16, v16, v16
    v_cvt_pk_bf16_f32 v17, v17, v17
    s_waitcnt vmcnt(40)
    v_and_b32 v18, v14, v4
    v_and_b32 v19, v14, v5
    v_and_b32 v20, v14, v6
    v_and_b32 v21, v14, v7
    s_nop 1
    v_mfma_f32_16x16x32_bf16 v[8:11], v[80:83], v[18:21], v[8:11]
    v_and_b32 v22, v15, v4
    v_and_b32 v23, v15, v5
    v_and_b32 v24, v15, v6
    v_and_b32 v25, v15, v7
    s_nop 1
    v_mfma_f32_16x16x32_bf16 v[8:11], v[84:87], v[22:25], v[8:11]
    v_and_b32 v18, v16, v4
    v_and_b32 v19, v16, v5
    v_and_b32 v20, v16, v6
    v_and_b32 v21, v16, v7
    s_nop 1
    v_mfma_f32_16x16x32_bf16 v[8:11], v[88:91], v[18:21], v[8:11]
    v_and_b32 v22, v17, v4
    v_and_b32 v23, v17, v5
    v_and_b32 v24, v17, v6
    v_and_b32 v25, v17, v7
    s_nop 1
    v_mfma_f32_16x16x32_bf16 v[8:11], v[92:95], v[22:25], v[8:11]
    s_waitcnt vmcnt(36)
    v_mfma_f32_16x16x32_bf16 v[14:17], v[96:99], v[32:35], 0
    v_mfma_f32_16x16x32_bf16 v[14:17], v[100:103], v[36:39], v[14:17]
    v_mfma_f32_16x16x32_bf16 v[14:17], v[104:107], v[40:43], v[14:17]
    v_mfma_f32_16x16x32_bf16 v[14:17], v[108:111], v[44:47], v[14:17]
    s_nop 7
    v_max3_f32 v26, v14, v15, v16
    v_max3_f32 v26, v26, v17, v12
    v_mov_b32 v27, v26
    s_nop 1
    v_permlane16_swap_b32 v26, v27
    s_nop 0
    v_max_f32 v26, v26, v27
    v_mov_b32 v27, v26
    s_nop 1
    v_permlane32_swap_b32 v26, v27
    s_nop 0
    v_max_f32 v26, v26, v27
    v_sub_f32 v27, v12, v26
    v_mul_f32 v27, s32, v27
    v_exp_f32 v27, v27
    v_mov_b32 v12, v26
    v_mul_f32 v26, s32, v26
    v_fma_f32 v14, v14, s32, -v26
    v_fma_f32 v15, v15, s32, -v26
    v_fma_f32 v16, v16, s32, -v26
    v_fma_f32 v17, v17, s32, -v26
    v_exp_f32 v14, v14
    v_exp_f32 v15, v15
    v_exp_f32 v16, v16
    v_exp_f32 v17, v17
    v_mul_f32 v8, v27, v8
    v_mul_f32 v9, v27, v9
    v_mul_f32 v10, v27, v10
    v_mul_f32 v11, v27, v11
    v_add_f32 v28, v14, v15
    v_add_f32 v29, v16, v17
    v_fma_f32 v13, v13, v27, v28
    v_add_f32 v13, v13, v29
    v_cvt_pk_bf16_f32 v14, v14, v14
    v_cvt_pk_bf16_f32 v15, v15, v15
    v_cvt_pk_bf16_f32 v16, v16, v16
    v_cvt_pk_bf16_f32 v17, v17, v17
    s_waitcnt vmcnt(32)
    v_and_b32 v18, v14, v4
    v_and_b32 v19, v14, v5
    v_and_b32 v20, v14, v6
    v_and_b32 v21, v14, v7
    s_nop 1
    v_mfma_f32_16x16x32_bf16 v[8:11], v[112:115], v[18:21], v[8:11]
    v_and_b32 v22, v15, v4
    v_and_b32 v23, v15, v5
    v_and_b32 v24, v15, v6
    v_and_b32 v25, v15, v7
    s_nop 1
    v_mfma_f32_16x16x32_bf16 v[8:11], v[116:119], v[22:25], v[8:11]
    v_and_b32 v18, v16, v4
    v_and_b32 v19, v16, v5
    v_and_b32 v20, v16, v6
    v_and_b32 v21, v16, v7
    s_nop 1
    v_mfma_f32_16x16x32_bf16 v[8:11], v[120:123], v[18:21], v[8:11]
    v_and_b32 v22, v17, v4
    v_and_b32 v23, v17, v5
    v_and_b32 v24, v17, v6
    v_and_b32 v25, v17, v7
    s_nop 1
    v_mfma_f32_16x16x32_bf16 v[8:11], v[124:127], v[22:25], v[8:11]
    s_waitcnt vmcnt(28)
    v_mfma_f32_16x16x32_bf16 v[14:17], v[128:131], v[32:35], 0
    v_mfma_f32_16x16x32_bf16 v[14:17], v[132:135], v[36:39], v[14:17]
    v_mfma_f32_16x16x32_bf16 v[14:17], v[136:139], v[40:43], v[14:17]
    v_mfma_f32_16x16x32_bf16 v[14:17], v[140:143], v[44:47], v[14:17]
    s_nop 7
    v_max3_f32 v26, v14, v15, v16
    v_max3_f32 v26, v26, v17, v12
    v_mov_b32 v27, v26
    s_nop 1
    v_permlane16_swap_b32 v26, v27
    s_nop 0
    v_max_f32 v26, v26, v27
    v_mov_b32 v27, v26
    s_nop 1
    v_permlane32_swap_b32 v26, v27
    s_nop 0
    v_max_f32 v26, v26, v27
    v_sub_f32 v27, v12, v26
    v_mul_f32 v27, s32, v27
    v_exp_f32 v27, v27
    v_mov_b32 v12, v26
    v_mul_f32 v26, s32, v26
    v_fma_f32 v14, v14, s32, -v26
    v_fma_f32 v15, v15, s32, -v26
    v_fma_f32 v16, v16, s32, -v26
    v_fma_f32 v17, v17, s32, -v26
    v_exp_f32 v14, v14
    v_exp_f32 v15, v15
    v_exp_f32 v16, v16
    v_exp_f32 v17, v17
    v_mul_f32 v8, v27, v8
    v_mul_f32 v9, v27, v9
    v_mul_f32 v10, v27, v10
    v_mul_f32 v11, v27, v11
    v_add_f32 v28, v14, v15
    v_add_f32 v29, v16, v17
    v_fma_f32 v13, v13, v27, v28
    v_add_f32 v13, v13, v29
    v_cvt_pk_bf16_f32 v14, v14, v14
    v_cvt_pk_bf16_f32 v15, v15, v15
    v_cvt_pk_bf16_f32 v16, v16, v16
    v_cvt_pk_bf16_f32 v17, v17, v17
    s_waitcnt vmcnt(24)
    v_and_b32 v18, v14, v4
    v_and_b32 v19, v14, v5
    v_and_b32 v20, v14, v6
    v_and_b32 v21, v14, v7
    s_nop 1
    v_mfma_f32_16x16x32_bf16 v[8:11], v[144:147], v[18:21], v[8:11]
    v_and_b32 v22, v15, v4
    v_and_b32 v23, v15, v5
    v_and_b32 v24, v15, v6
    v_and_b32 v25, v15, v7
    s_nop 1
    v_mfma_f32_16x16x32_bf16 v[8:11], v[148:151], v[22:25], v[8:11]
    v_and_b32 v18, v16, v4
    v_and_b32 v19, v16, v5
    v_and_b32 v20, v16, v6
    v_and_b32 v21, v16, v7
    s_nop 1
    v_mfma_f32_16x16x32_bf16 v[8:11], v[152:155], v[18:21], v[8:11]
    v_and_b32 v22, v17, v4
    v_and_b32 v23, v17, v5
    v_and_b32 v24, v17, v6
    v_and_b32 v25, v17, v7
    s_nop 1
    v_mfma_f32_16x16x32_bf16 v[8:11], v[156:159], v[22:25], v[8:11]
    s_waitcnt vmcnt(20)
    v_mfma_f32_16x16x32_bf16 v[14:17], v[160:163], v[32:35], 0
    v_mfma_f32_16x16x32_bf16 v[14:17], v[164:167], v[36:39], v[14:17]
    v_mfma_f32_16x16x32_bf16 v[14:17], v[168:171], v[40:43], v[14:17]
    v_mfma_f32_16x16x32_bf16 v[14:17], v[172:175], v[44:47], v[14:17]
    s_nop 7
    v_max3_f32 v26, v14, v15, v16
    v_max3_f32 v26, v26, v17, v12
    v_mov_b32 v27, v26
    s_nop 1
    v_permlane16_swap_b32 v26, v27
    s_nop 0
    v_max_f32 v26, v26, v27
    v_mov_b32 v27, v26
    s_nop 1
    v_permlane32_swap_b32 v26, v27
    s_nop 0
    v_max_f32 v26, v26, v27
    v_sub_f32 v27, v12, v26
    v_mul_f32 v27, s32, v27
    v_exp_f32 v27, v27
    v_mov_b32 v12, v26
    v_mul_f32 v26, s32, v26
    v_fma_f32 v14, v14, s32, -v26
    v_fma_f32 v15, v15, s32, -v26
    v_fma_f32 v16, v16, s32, -v26
    v_fma_f32 v17, v17, s32, -v26
    v_exp_f32 v14, v14
    v_exp_f32 v15, v15
    v_exp_f32 v16, v16
    v_exp_f32 v17, v17
    v_mul_f32 v8, v27, v8
    v_mul_f32 v9, v27, v9
    v_mul_f32 v10, v27, v10
    v_mul_f32 v11, v27, v11
    v_add_f32 v28, v14, v15
    v_add_f32 v29, v16, v17
    v_fma_f32 v13, v13, v27, v28
    v_add_f32 v13, v13, v29
    v_cvt_pk_bf16_f32 v14, v14, v14
    v_cvt_pk_bf16_f32 v15, v15, v15
    v_cvt_pk_bf16_f32 v16, v16, v16
    v_cvt_pk_bf16_f32 v17, v17, v17
    s_waitcnt vmcnt(16)
    v_and_b32 v18, v14, v4
    v_and_b32 v19, v14, v5
    v_and_b32 v20, v14, v6
    v_and_b32 v21, v14, v7
    s_nop 1
    v_mfma_f32_16x16x32_bf16 v[8:11], v[176:179], v[18:21], v[8:11]
    v_and_b32 v22, v15, v4
    v_and_b32 v23, v15, v5
    v_and_b32 v24, v15, v6
    v_and_b32 v25, v15, v7
    s_nop 1
    v_mfma_f32_16x16x32_bf16 v[8:11], v[180:183], v[22:25], v[8:11]
    v_and_b32 v18, v16, v4
    v_and_b32 v19, v16, v5
    v_and_b32 v20, v16, v6
    v_and_b32 v21, v16, v7
    s_nop 1
    v_mfma_f32_16x16x32_bf16 v[8:11], v[184:187], v[18:21], v[8:11]
    v_and_b32 v22, v17, v4
    v_and_b32 v23, v17, v5
    v_and_b32 v24, v17, v6
    v_and_b32 v25, v17, v7
    s_nop 1
    v_mfma_f32_16x16x32_bf16 v[8:11], v[188:191], v[22:25], v[8:11]
    s_waitcnt vmcnt(12)
    v_mfma_f32_16x16x32_bf16 v[14:17], v[192:195], v[32:35], 0
    v_mfma_f32_16x16x32_bf16 v[14:17], v[196:199], v[36:39], v[14:17]
    v_mfma_f32_16x16x32_bf16 v[14:17], v[200:203], v[40:43], v[14:17]
    v_mfma_f32_16x16x32_bf16 v[14:17], v[204:207], v[44:47], v[14:17]
    buffer_load_dwordx4 v[64:67], v48, s[4:7], s28 offen offset:0 nt
    buffer_load_dwordx4 v[68:71], v48, s[4:7], s28 offen offset:64 nt
    buffer_load_dwordx4 v[72:75], v48, s[4:7], s28 offen offset:128 nt
    buffer_load_dwordx4 v[76:79], v48, s[4:7], s28 offen offset:192 nt
    s_nop 3
    v_max3_f32 v26, v14, v15, v16
    v_max3_f32 v26, v26, v17, v12
    v_mov_b32 v27, v26
    s_nop 1
    v_permlane16_swap_b32 v26, v27
    s_nop 0
    v_max_f32 v26, v26, v27
    v_mov_b32 v27, v26
    s_nop 1
    v_permlane32_swap_b32 v26, v27
    s_nop 0
    v_max_f32 v26, v26, v27
    v_sub_f32 v27, v12, v26
    v_mul_f32 v27, s32, v27
    v_exp_f32 v27, v27
    v_mov_b32 v12, v26
    v_mul_f32 v26, s32, v26
    v_fma_f32 v14, v14, s32, -v26
    v_fma_f32 v15, v15, s32, -v26
    v_fma_f32 v16, v16, s32, -v26
    v_fma_f32 v17, v17, s32, -v26
    v_exp_f32 v14, v14
    v_exp_f32 v15, v15
    v_exp_f32 v16, v16
    v_exp_f32 v17, v17
    v_mul_f32 v8, v27, v8
    v_mul_f32 v9, v27, v9
    v_mul_f32 v10, v27, v10
    v_mul_f32 v11, v27, v11
    v_add_f32 v28, v14, v15
    v_add_f32 v29, v16, v17
    v_fma_f32 v13, v13, v27, v28
    v_add_f32 v13, v13, v29
    v_cvt_pk_bf16_f32 v14, v14, v14
    v_cvt_pk_bf16_f32 v15, v15, v15
    v_cvt_pk_bf16_f32 v16, v16, v16
    v_cvt_pk_bf16_f32 v17, v17, v17
    s_waitcnt vmcnt(12)
    v_and_b32 v18, v14, v4
    v_and_b32 v19, v14, v5
    v_and_b32 v20, v14, v6
    v_and_b32 v21, v14, v7
    s_nop 1
    v_mfma_f32_16x16x32_bf16 v[8:11], v[208:211], v[18:21], v[8:11]
    v_and_b32 v22, v15, v4
    v_and_b32 v23, v15, v5
    v_and_b32 v24, v15, v6
    v_and_b32 v25, v15, v7
    s_nop 1
    v_mfma_f32_16x16x32_bf16 v[8:11], v[212:215], v[22:25], v[8:11]
    v_and_b32 v18, v16, v4
    v_and_b32 v19, v16, v5
    v_and_b32 v20, v16, v6
    v_and_b32 v21, v16, v7
    s_nop 1
    v_mfma_f32_16x16x32_bf16 v[8:11], v[216:219], v[18:21], v[8:11]
    v_and_b32 v22, v17, v4
    v_and_b32 v23, v17, v5
    v_and_b32 v24, v17, v6
    v_and_b32 v25, v17, v7
    s_nop 1
    v_mfma_f32_16x16x32_bf16 v[8:11], v[220:223], v[22:25], v[8:11]
    buffer_load_dwordx4 v[80:83], v49, s[8:11], s28 offen offset:0 nt
    buffer_load_dwordx4 v[84:87], v49, s[8:11], s28 offen offset:256 nt
    buffer_load_dwordx4 v[88:91], v49, s[8:11], s28 offen offset:512 nt
    buffer_load_dwordx4 v[92:95], v49, s[8:11], s28 offen offset:768 nt
    s_add_u32 s28, s28, s68
    s_waitcnt vmcnt(12)
    v_mfma_f32_16x16x32_bf16 v[14:17], v[224:227], v[32:35], 0
    v_mfma_f32_16x16x32_bf16 v[14:17], v[228:231], v[36:39], v[14:17]
    v_mfma_f32_16x16x32_bf16 v[14:17], v[232:235], v[40:43], v[14:17]
    v_mfma_f32_16x16x32_bf16 v[14:17], v[236:239], v[44:47], v[14:17]
    buffer_load_dwordx4 v[96:99], v48, s[4:7], s28 offen offset:0 nt
    buffer_load_dwordx4 v[100:103], v48, s[4:7], s28 offen offset:64 nt
    buffer_load_dwordx4 v[104:107], v48, s[4:7], s28 offen offset:128 nt
    buffer_load_dwordx4 v[108:111], v48, s[4:7], s28 offen offset:192 nt
    s_nop 3
    v_max3_f32 v26, v14, v15, v16
    v_max3_f32 v26, v26, v17, v12
    v_mov_b32 v27, v26
    s_nop 1
    v_permlane16_swap_b32 v26, v27
    s_nop 0
    v_max_f32 v26, v26, v27
    v_mov_b32 v27, v26
    s_nop 1
    v_permlane32_swap_b32 v26, v27
    s_nop 0
    v_max_f32 v26, v26, v27
    v_sub_f32 v27, v12, v26
    v_mul_f32 v27, s32, v27
    v_exp_f32 v27, v27
    v_mov_b32 v12, v26
    v_mul_f32 v26, s32, v26
    v_fma_f32 v14, v14, s32, -v26
    v_fma_f32 v15, v15, s32, -v26
    v_fma_f32 v16, v16, s32, -v26
    v_fma_f32 v17, v17, s32, -v26
    v_exp_f32 v14, v14
    v_exp_f32 v15, v15
    v_exp_f32 v16, v16
    v_exp_f32 v17, v17
    v_mul_f32 v8, v27, v8
    v_mul_f32 v9, v27, v9
    v_mul_f32 v10, v27, v10
    v_mul_f32 v11, v27, v11
    v_add_f32 v28, v14, v15
    v_add_f32 v29, v16, v17
    v_fma_f32 v13, v13, v27, v28
    v_add_f32 v13, v13, v29
    v_cvt_pk_bf16_f32 v14, v14, v14
    v_cvt_pk_bf16_f32 v15, v15, v15
    v_cvt_pk_bf16_f32 v16, v16, v16
    v_cvt_pk_bf16_f32 v17, v17, v17
    s_waitcnt vmcnt(12)
    v_and_b32 v18, v14, v4
    v_and_b32 v19, v14, v5
    v_and_b32 v20, v14, v6
    v_and_b32 v21, v14, v7
    s_nop 1
    v_mfma_f32_16x16x32_bf16 v[8:11], v[240:243], v[18:21], v[8:11]
    v_and_b32 v22, v15, v4
    v_and_b32 v23, v15, v5
    v_and_b32 v24, v15, v6
    v_and_b32 v25, v15, v7
    s_nop 1
    v_mfma_f32_16x16x32_bf16 v[8:11], v[244:247], v[22:25], v[8:11]
    v_and_b32 v18, v16, v4
    v_and_b32 v19, v16, v5
    v_and_b32 v20, v16, v6
    v_and_b32 v21, v16, v7
    s_nop 1
    v_mfma_f32_16x16x32_bf16 v[8:11], v[248:251], v[18:21], v[8:11]
    v_and_b32 v22, v17, v4
    v_and_b32 v23, v17, v5
    v_and_b32 v24, v17, v6
    v_and_b32 v25, v17, v7
    s_nop 1
    v_mfma_f32_16x16x32_bf16 v[8:11], v[252:255], v[22:25], v[8:11]
    buffer_load_dwordx4 v[112:115], v49, s[8:11], s28 offen offset:0 nt
    buffer_load_dwordx4 v[116:119], v49, s[8:11], s28 offen offset:256 nt
    buffer_load_dwordx4 v[120:123], v49, s[8:11], s28 offen offset:512 nt
    buffer_load_dwordx4 v[124:127], v49, s[8:11], s28 offen offset:768 nt
    s_add_u32 s28, s28, s68
    s_mov_b32 s29, 25
L_loop:
    s_waitcnt vmcnt(12)
    v_mfma_f32_16x16x32_bf16 v[14:17], v[64:67], v[32:35], 0
    v_mfma_f32_16x16x32_bf16 v[14:17], v[68:71], v[36:39], v[14:17]
    v_mfma_f32_16x16x32_bf16 v[14:17], v[72:75], v[40:43], v[14:17]
    v_mfma_f32_16x16x32_bf16 v[14:17], v[76:79], v[44:47], v[14:17]
    buffer_load_dwordx4 v[64:67], v48, s[4:7], s28 offen offset:0 nt
    buffer_load_dwordx4 v[68:71], v48, s[4:7], s28 offen offset:64 nt
    buffer_load_dwordx4 v[72:75], v48, s[4:7], s28 offen offset:128 nt
    buffer_load_dwordx4 v[76:79], v48, s[4:7], s28 offen offset:192 nt
    s_nop 3
    v_max3_f32 v26, v14, v15, v16
    v_max3_f32 v26, v26, v17, v12
    v_mov_b32 v27, v26
    s_nop 1
    v_permlane16_swap_b32 v26, v27
    s_nop 0
    v_max_f32 v26, v26, v27
    v_mov_b32 v27, v26
    s_nop 1
    v_permlane32_swap_b32 v26, v27
    s_nop 0
    v_max_f32 v26, v26, v27
    v_sub_f32 v27, v12, v26
    v_mul_f32 v27, s32, v27
    v_exp_f32 v27, v27
    v_mov_b32 v12, v26
    v_mul_f32 v26, s32, v26
    v_fma_f32 v14, v14, s32, -v26
    v_fma_f32 v15, v15, s32, -v26
    v_fma_f32 v16, v16, s32, -v26
    v_fma_f32 v17, v17, s32, -v26
    v_exp_f32 v14, v14
    v_exp_f32 v15, v15
    v_exp_f32 v16, v16
    v_exp_f32 v17, v17
    v_mul_f32 v8, v27, v8
    v_mul_f32 v9, v27, v9
    v_mul_f32 v10, v27, v10
    v_mul_f32 v11, v27, v11
    v_add_f32 v28, v14, v15
    v_add_f32 v29, v16, v17
    v_fma_f32 v13, v13, v27, v28
    v_add_f32 v13, v13, v29
    v_cvt_pk_bf16_f32 v14, v14, v14
    v_cvt_pk_bf16_f32 v15, v15, v15
    v_cvt_pk_bf16_f32 v16, v16, v16
    v_cvt_pk_bf16_f32 v17, v17, v17
    s_waitcnt vmcnt(12)
    v_and_b32 v18, v14, v4
    v_and_b32 v19, v14, v5
    v_and_b32 v20, v14, v6
    v_and_b32 v21, v14, v7
    s_nop 1
    v_mfma_f32_16x16x32_bf16 v[8:11], v[80:83], v[18:21], v[8:11]
    v_and_b32 v22, v15, v4
    v_and_b32 v23, v15, v5
    v_and_b32 v24, v15, v6
    v_and_b32 v25, v15, v7
    s_nop 1
    v_mfma_f32_16x16x32_bf16 v[8:11], v[84:87], v[22:25], v[8:11]
    v_and_b32 v18, v16, v4
    v_and_b32 v19, v16, v5
    v_and_b32 v20, v16, v6
    v_and_b32 v21, v16, v7
    s_nop 1
    v_mfma_f32_16x16x32_bf16 v[8:11], v[88:91], v[18:21], v[8:11]
    v_and_b32 v22, v17, v4
    v_and_b32 v23, v17, v5
    v_and_b32 v24, v17, v6
    v_and_b32 v25, v17, v7
    s_nop 1
    v_mfma_f32_16x16x32_bf16 v[8:11], v[92:95], v[22:25], v[8:11]
    buffer_load_dwordx4 v[80:83], v49, s[8:11], s28 offen offset:0 nt
    buffer_load_dwordx4 v[84:87], v49, s[8:11], s28 offen offset:256 nt
    buffer_load_dwordx4 v[88:91], v49, s[8:11], s28 offen offset:512 nt
    buffer_load_dwordx4 v[92:95], v49, s[8:11], s28 offen offset:768 nt
    s_add_u32 s28, s28, s68
    s_waitcnt vmcnt(12)
    v_mfma_f32_16x16x32_bf16 v[14:17], v[96:99], v[32:35], 0
    v_mfma_f32_16x16x32_bf16 v[14:17], v[100:103], v[36:39], v[14:17]
    v_mfma_f32_16x16x32_bf16 v[14:17], v[104:107], v[40:43], v[14:17]
    v_mfma_f32_16x16x32_bf16 v[14:17], v[108:111], v[44:47], v[14:17]
    buffer_load_dwordx4 v[96:99], v48, s[4:7], s28 offen offset:0 nt
    buffer_load_dwordx4 v[100:103], v48, s[4:7], s28 offen offset:64 nt
    buffer_load_dwordx4 v[104:107], v48, s[4:7], s28 offen offset:128 nt
    buffer_load_dwordx4 v[108:111], v48, s[4:7], s28 offen offset:192 nt
    s_nop 3
    v_max3_f32 v26, v14, v15, v16
    v_max3_f32 v26, v26, v17, v12
    v_mov_b32 v27, v26
    s_nop 1
    v_permlane16_swap_b32 v26, v27
    s_nop 0
    v_max_f32 v26, v26, v27
    v_mov_b32 v27, v26
    s_nop 1
    v_permlane32_swap_b32 v26, v27
    s_nop 0
    v_max_f32 v26, v26, v27
    v_sub_f32 v27, v12, v26
    v_mul_f32 v27, s32, v27
    v_exp_f32 v27, v27
    v_mov_b32 v12, v26
    v_mul_f32 v26, s32, v26
    v_fma_f32 v14, v14, s32, -v26
    v_fma_f32 v15, v15, s32, -v26
    v_fma_f32 v16, v16, s32, -v26
    v_fma_f32 v17, v17, s32, -v26
    v_exp_f32 v14, v14
    v_exp_f32 v15, v15
    v_exp_f32 v16, v16
    v_exp_f32 v17, v17
    v_mul_f32 v8, v27, v8
    v_mul_f32 v9, v27, v9
    v_mul_f32 v10, v27, v10
    v_mul_f32 v11, v27, v11
    v_add_f32 v28, v14, v15
    v_add_f32 v29, v16, v17
    v_fma_f32 v13, v13, v27, v28
    v_add_f32 v13, v13, v29
    v_cvt_pk_bf16_f32 v14, v14, v14
    v_cvt_pk_bf16_f32 v15, v15, v15
    v_cvt_pk_bf16_f32 v16, v16, v16
    v_cvt_pk_bf16_f32 v17, v17, v17
    s_waitcnt vmcnt(12)
    v_and_b32 v18, v14, v4
    v_and_b32 v19, v14, v5
    v_and_b32 v20, v14, v6
    v_and_b32 v21, v14, v7
    s_nop 1
    v_mfma_f32_16x16x32_bf16 v[8:11], v[112:115], v[18:21], v[8:11]
    v_and_b32 v22, v15, v4
    v_and_b32 v23, v15, v5
    v_and_b32 v24, v15, v6
    v_and_b32 v25, v15, v7
    s_nop 1
    v_mfma_f32_16x16x32_bf16 v[8:11], v[116:119], v[22:25], v[8:11]
    v_and_b32 v18, v16, v4
    v_and_b32 v19, v16, v5
    v_and_b32 v20, v16, v6
    v_and_b32 v21, v16, v7
    s_nop 1
    v_mfma_f32_16x16x32_bf16 v[8:11], v[120:123], v[18:21], v[8:11]
    v_and_b32 v22, v17, v4
    v_and_b32 v23, v17, v5
    v_and_b32 v24, v17, v6
    v_and_b32 v25, v17, v7
    s_nop 1
    v_mfma_f32_16x16x32_bf16 v[8:11], v[124:127], v[22:25], v[8:11]
    buffer_load_dwordx4 v[112:115], v49, s[8:11], s28 offen offset:0 nt
    buffer_load_dwordx4 v[116:119], v49, s[8:11], s28 offen offset:256 nt
    buffer_load_dwordx4 v[120:123], v49, s[8:11], s28 offen offset:512 nt
    buffer_load_dwordx4 v[124:127], v49, s[8:11], s28 offen offset:768 nt
    s_add_u32 s28, s28, s68
    s_sub_u32 s29, s29, 1
    s_cmp_lg_u32 s29, 0
    s_cbranch_scc1 L_loop
    s_waitcnt vmcnt(12)
    v_mfma_f32_16x16x32_bf16 v[14:17], v[64:67], v[32:35], 0
    v_mfma_f32_16x16x32_bf16 v[14:17], v[68:71], v[36:39], v[14:17]
    v_mfma_f32_16x16x32_bf16 v[14:17], v[72:75], v[40:43], v[14:17]
    v_mfma_f32_16x16x32_bf16 v[14:17], v[76:79], v[44:47], v[14:17]
    s_mov_b64 exec, 1
    v_mov_b32 v53, 1
    buffer_atomic_add v53, v52, s[24:27], s69 offen sc0
    s_mov_b64 exec, -1
    buffer_load_dwordx4 v[64:67], v48, s[4:7], s28 offen offset:0 nt
    buffer_load_dwordx4 v[68:71], v48, s[4:7], s28 offen offset:64 nt
    buffer_load_dwordx4 v[72:75], v48, s[4:7], s28 offen offset:128 nt
    buffer_load_dwordx4 v[76:79], v48, s[4:7], s28 offen offset:192 nt
    s_nop 3
    v_max3_f32 v26, v14, v15, v16
    v_max3_f32 v26, v26, v17, v12
    v_mov_b32 v27, v26
    s_nop 1
    v_permlane16_swap_b32 v26, v27
    s_nop 0
    v_max_f32 v26, v26, v27
    v_mov_b32 v27, v26
    s_nop 1
    v_permlane32_swap_b32 v26, v27
    s_nop 0
    v_max_f32 v26, v26, v27
    v_sub_f32 v27, v12, v26
    v_mul_f32 v27, s32, v27
    v_exp_f32 v27, v27
    v_mov_b32 v12, v26
    v_mul_f32 v26, s32, v26
    v_fma_f32 v14, v14, s32, -v26
    v_fma_f32 v15, v15, s32, -v26
    v_fma_f32 v16, v16, s32, -v26
    v_fma_f32 v17, v17, s32, -v26
    v_exp_f32 v14, v14
    v_exp_f32 v15, v15
    v_exp_f32 v16, v16
    v_exp_f32 v17, v17
    v_mul_f32 v8, v27, v8
    v_mul_f32 v9, v27, v9
    v_mul_f32 v10, v27, v10
    v_mul_f32 v11, v27, v11
    v_add_f32 v28, v14, v15
    v_add_f32 v29, v16, v17
    v_fma_f32 v13, v13, v27, v28
    v_add_f32 v13, v13, v29
    v_cvt_pk_bf16_f32 v14, v14, v14
    v_cvt_pk_bf16_f32 v15, v15, v15
    v_cvt_pk_bf16_f32 v16, v16, v16
    v_cvt_pk_bf16_f32 v17, v17, v17
    s_waitcnt vmcnt(13)
    v_and_b32 v18, v14, v4
    v_and_b32 v19, v14, v5
    v_and_b32 v20, v14, v6
    v_and_b32 v21, v14, v7
    s_nop 1
    v_mfma_f32_16x16x32_bf16 v[8:11], v[80:83], v[18:21], v[8:11]
    v_and_b32 v22, v15, v4
    v_and_b32 v23, v15, v5
    v_and_b32 v24, v15, v6
    v_and_b32 v25, v15, v7
    s_nop 1
    v_mfma_f32_16x16x32_bf16 v[8:11], v[84:87], v[22:25], v[8:11]
    v_and_b32 v18, v16, v4
    v_and_b32 v19, v16, v5
    v_and_b32 v20, v16, v6
    v_and_b32 v21, v16, v7
    s_nop 1
    v_mfma_f32_16x16x32_bf16 v[8:11], v[88:91], v[18:21], v[8:11]
    v_and_b32 v22, v17, v4
    v_and_b32 v23, v17, v5
    v_and_b32 v24, v17, v6
    v_and_b32 v25, v17, v7
    s_nop 1
    v_mfma_f32_16x16x32_bf16 v[8:11], v[92:95], v[22:25], v[8:11]
    buffer_load_dwordx4 v[80:83], v49, s[8:11], s28 offen offset:0 nt
    buffer_load_dwordx4 v[84:87], v49, s[8:11], s28 offen offset:256 nt
    buffer_load_dwordx4 v[88:91], v49, s[8:11], s28 offen offset:512 nt
    buffer_load_dwordx4 v[92:95], v49, s[8:11], s28 offen offset:768 nt
    s_add_u32 s28, s28, s68
    s_waitcnt vmcnt(13)
    v_mfma_f32_16x16x32_bf16 v[14:17], v[96:99], v[32:35], 0
    v_mfma_f32_16x16x32_bf16 v[14:17], v[100:103], v[36:39], v[14:17]
    v_mfma_f32_16x16x32_bf16 v[14:17], v[104:107], v[40:43], v[14:17]
    v_mfma_f32_16x16x32_bf16 v[14:17], v[108:111], v[44:47], v[14:17]
    buffer_load_dwordx4 v[96:99], v48, s[4:7], s28 offen offset:0 nt
    buffer_load_dwordx4 v[100:103], v48, s[4:7], s28 offen offset:64 nt
    buffer_load_dwordx4 v[104:107], v48, s[4:7], s28 offen offset:128 nt
    buffer_load_dwordx4 v[108:111], v48, s[4:7], s28 offen offset:192 nt
    s_nop 3
    v_max3_f32 v26, v14, v15, v16
    v_max3_f32 v26, v26, v17, v12
    v_mov_b32 v27, v26
    s_nop 1
    v_permlane16_swap_b32 v26, v27
    s_nop 0
    v_max_f32 v26, v26, v27
    v_mov_b32 v27, v26
    s_nop 1
    v_permlane32_swap_b32 v26, v27
    s_nop 0
    v_max_f32 v26, v26, v27
    v_sub_f32 v27, v12, v26
    v_mul_f32 v27, s32, v27
    v_exp_f32 v27, v27
    v_mov_b32 v12, v26
    v_mul_f32 v26, s32, v26
    v_fma_f32 v14, v14, s32, -v26
    v_fma_f32 v15, v15, s32, -v26
    v_fma_f32 v16, v16, s32, -v26
    v_fma_f32 v17, v17, s32, -v26
    v_exp_f32 v14, v14
    v_exp_f32 v15, v15
    v_exp_f32 v16, v16
    v_exp_f32 v17, v17
    v_mul_f32 v8, v27, v8
    v_mul_f32 v9, v27, v9
    v_mul_f32 v10, v27, v10
    v_mul_f32 v11, v27, v11
    v_add_f32 v28, v14, v15
    v_add_f32 v29, v16, v17
    v_fma_f32 v13, v13, v27, v28
    v_add_f32 v13, v13, v29
    v_cvt_pk_bf16_f32 v14, v14, v14
    v_cvt_pk_bf16_f32 v15, v15, v15
    v_cvt_pk_bf16_f32 v16, v16, v16
    v_cvt_pk_bf16_f32 v17, v17, v17
    s_waitcnt vmcnt(13)
    v_and_b32 v18, v14, v4
    v_and_b32 v19, v14, v5
    v_and_b32 v20, v14, v6
    v_and_b32 v21, v14, v7
    s_nop 1
    v_mfma_f32_16x16x32_bf16 v[8:11], v[112:115], v[18:21], v[8:11]
    v_and_b32 v22, v15, v4
    v_and_b32 v23, v15, v5
    v_and_b32 v24, v15, v6
    v_and_b32 v25, v15, v7
    s_nop 1
    v_mfma_f32_16x16x32_bf16 v[8:11], v[116:119], v[22:25], v[8:11]
    v_and_b32 v18, v16, v4
    v_and_b32 v19, v16, v5
    v_and_b32 v20, v16, v6
    v_and_b32 v21, v16, v7
    s_nop 1
    v_mfma_f32_16x16x32_bf16 v[8:11], v[120:123], v[18:21], v[8:11]
    v_and_b32 v22, v17, v4
    v_and_b32 v23, v17, v5
    v_and_b32 v24, v17, v6
    v_and_b32 v25, v17, v7
    s_nop 1
    v_mfma_f32_16x16x32_bf16 v[8:11], v[124:127], v[22:25], v[8:11]
    buffer_load_dwordx4 v[112:115], v49, s[8:11], s28 offen offset:0 nt
    buffer_load_dwordx4 v[116:119], v49, s[8:11], s28 offen offset:256 nt
    buffer_load_dwordx4 v[120:123], v49, s[8:11], s28 offen offset:512 nt
    buffer_load_dwordx4 v[124:127], v49, s[8:11], s28 offen offset:768 nt
    s_add_u32 s28, s28, s68
    s_mov_b32 s68, 4096
    s_add_u32 s79, s79, 1966080
L_dyn:
    s_waitcnt vmcnt(12)
    v_readfirstlane_b32 s62, v53
    s_nop 0
L_tk:
    s_lshr_b32 s63, s62, 10
    s_cmp_lg_u32 s63, s78
    s_cbranch_scc1 L_tkslow
    s_and_b32 s62, s62, 1023
    s_cmp_ge_u32 s62, 16
    s_cbranch_scc1 L_drain
    s_lshl_b32 s28, s62, 13
    s_add_u32 s28, s28, s79
    v_mfma_f32_16x16x32_bf16 v[14:17], v[64:67], v[32:35], 0
    v_mfma_f32_16x16x32_bf16 v[14:17], v[68:71], v[36:39], v[14:17]
    v_mfma_f32_16x16x32_bf16 v[14:17], v[72:75], v[40:43], v[14:17]
    v_mfma_f32_16x16x32_bf16 v[14:17], v[76:79], v[44:47], v[14:17]
    s_mov_b64 exec, 1
    v_mov_b32 v53, 1
    buffer_atomic_add v53, v52, s[24:27], s69 offen sc0
    s_mov_b64 exec, -1
    buffer_load_dwordx4 v[64:67], v48, s[4:7], s28 offen offset:0 nt
    buffer_load_dwordx4 v[68:71], v48, s[4:7], s28 offen offset:64 nt
    buffer_load_dwordx4 v[72:75], v48, s[4:7], s28 offen offset:128 nt
    buffer_load_dwordx4 v[76:79], v48, s[4:7], s28 offen offset:192 nt
    s_nop 3
    v_max3_f32 v26, v14, v15, v16
    v_max3_f32 v26, v26, v17, v12
    v_mov_b32 v27, v26
    s_nop 1
    v_permlane16_swap_b32 v26, v27
    s_nop 0
    v_max_f32 v26, v26, v27
    v_mov_b32 v27, v26
    s_nop 1
    v_permlane32_swap_b32 v26, v27
    s_nop 0
    v_max_f32 v26, v26, v27
    v_sub_f32 v27, v12, v26
    v_mul_f32 v27, s32, v27
    v_exp_f32 v27, v27
    v_mov_b32 v12, v26
    v_mul_f32 v26, s32, v26
    v_fma_f32 v14, v14, s32, -v26
    v_fma_f32 v15, v15, s32, -v26
    v_fma_f32 v16, v16, s32, -v26
    v_fma_f32 v17, v17, s32, -v26
    v_exp_f32 v14, v14
    v_exp_f32 v15, v15
    v_exp_f32 v16, v16
    v_exp_f32 v17, v17
    v_mul_f32 v8, v27, v8
    v_mul_f32 v9, v27, v9
    v_mul_f32 v10, v27, v10
    v_mul_f32 v11, v27, v11
    v_add_f32 v28, v14, v15
    v_add_f32 v29, v16, v17
    v_fma_f32 v13, v13, v27, v28
    v_add_f32 v13, v13, v29
    v_cvt_pk_bf16_f32 v14, v14, v14
    v_cvt_pk_bf16_f32 v15, v15, v15
    v_cvt_pk_bf16_f32 v16, v16, v16
    v_cvt_pk_bf16_f32 v17, v17, v17
    s_waitcnt vmcnt(13)
    v_and_b32 v18, v14, v4
    v_and_b32 v19, v14, v5
    v_and_b32 v20, v14, v6
    v_and_b32 v21, v14, v7
    s_nop 1
    v_mfma_f32_16x16x32_bf16 v[8:11], v[80:83], v[18:21], v[8:11]
    v_and_b32 v22, v15, v4
    v_and_b32 v23, v15, v5
    v_and_b32 v24, v15, v6
    v_and_b32 v25, v15, v7
    s_nop 1
    v_mfma_f32_16x16x32_bf16 v[8:11], v[84:87], v[22:25], v[8:11]
    v_and_b32 v18, v16, v4
    v_and_b32 v19, v16, v5
    v_and_b32 v20, v16, v6
    v_and_b32 v21, v16, v7
    s_nop 1
    v_mfma_f32_16x16x32_bf16 v[8:11], v[88:91], v[18:21], v[8:11]
    v_and_b32 v22, v17, v4
    v_and_b32 v23, v17, v5
    v_and_b32 v24, v17, v6
    v_and_b32 v25, v17, v7
    s_nop 1
    v_mfma_f32_16x16x32_bf16 v[8:11], v[92:95], v[22:25], v[8:11]
    buffer_load_dwordx4 v[80:83], v49, s[8:11], s28 offen offset:0 nt
    buffer_load_dwordx4 v[84:87], v49, s[8:11], s28 offen offset:256 nt
    buffer_load_dwordx4 v[88:91], v49, s[8:11], s28 offen offset:512 nt
    buffer_load_dwordx4 v[92:95], v49, s[8:11], s28 offen offset:768 nt
    s_add_u32 s28, s28, s68
    s_waitcnt vmcnt(13)
    v_mfma_f32_16x16x32_bf16 v[14:17], v[96:99], v[32:35], 0
    v_mfma_f32_16x16x32_bf16 v[14:17], v[100:103], v[36:39], v[14:17]
    v_mfma_f32_16x16x32_bf16 v[14:17], v[104:107], v[40:43], v[14:17]
    v_mfma_f32_16x16x32_bf16 v[14:17], v[108:111], v[44:47], v[14:17]
    buffer_load_dwordx4 v[96:99], v48, s[4:7], s28 offen offset:0 nt
    buffer_load_dwordx4 v[100:103], v48, s[4:7], s28 offen offset:64 nt
    buffer_load_dwordx4 v[104:107], v48, s[4:7], s28 offen offset:128 nt
    buffer_load_dwordx4 v[108:111], v48, s[4:7], s28 offen offset:192 nt
    s_nop 3
    v_max3_f32 v26, v14, v15, v16
    v_max3_f32 v26, v26, v17, v12
    v_mov_b32 v27, v26
    s_nop 1
    v_permlane16_swap_b32 v26, v27
    s_nop 0
    v_max_f32 v26, v26, v27
    v_mov_b32 v27, v26
    s_nop 1
    v_permlane32_swap_b32 v26, v27
    s_nop 0
    v_max_f32 v26, v26, v27
    v_sub_f32 v27, v12, v26
    v_mul_f32 v27, s32, v27
    v_exp_f32 v27, v27
    v_mov_b32 v12, v26
    v_mul_f32 v26, s32, v26
    v_fma_f32 v14, v14, s32, -v26
    v_fma_f32 v15, v15, s32, -v26
    v_fma_f32 v16, v16, s32, -v26
    v_fma_f32 v17, v17, s32, -v26
    v_exp_f32 v14, v14
    v_exp_f32 v15, v15
    v_exp_f32 v16, v16
    v_exp_f32 v17, v17
    v_mul_f32 v8, v27, v8
    v_mul_f32 v9, v27, v9
    v_mul_f32 v10, v27, v10
    v_mul_f32 v11, v27, v11
    v_add_f32 v28, v14, v15
    v_add_f32 v29, v16, v17
    v_fma_f32 v13, v13, v27, v28
    v_add_f32 v13, v13, v29
    v_cvt_pk_bf16_f32 v14, v14, v14
    v_cvt_pk_bf16_f32 v15, v15, v15
    v_cvt_pk_bf16_f32 v16, v16, v16
    v_cvt_pk_bf16_f32 v17, v17, v17
    s_waitcnt vmcnt(13)
    v_and_b32 v18, v14, v4
    v_and_b32 v19, v14, v5
    v_and_b32 v20, v14, v6
    v_and_b32 v21, v14, v7
    s_nop 1
    v_mfma_f32_16x16x32_bf16 v[8:11], v[112:115], v[18:21], v[8:11]
    v_and_b32 v22, v15, v4
    v_and_b32 v23, v15, v5
    v_and_b32 v24, v15, v6
    v_and_b32 v25, v15, v7
    s_nop 1
    v_mfma_f32_16x16x32_bf16 v[8:11], v[116:119], v[22:25], v[8:11]
    v_and_b32 v18, v16, v4
    v_and_b32 v19, v16, v5
    v_and_b32 v20, v16, v6
    v_and_b32 v21, v16, v7
    s_nop 1
    v_mfma_f32_16x16x32_bf16 v[8:11], v[120:123], v[18:21], v[8:11]
    v_and_b32 v22, v17, v4
    v_and_b32 v23, v17, v5
    v_and_b32 v24, v17, v6
    v_and_b32 v25, v17, v7
    s_nop 1
    v_mfma_f32_16x16x32_bf16 v[8:11], v[124:127], v[22:25], v[8:11]
    buffer_load_dwordx4 v[112:115], v49, s[8:11], s28 offen offset:0 nt
    buffer_load_dwordx4 v[116:119], v49, s[8:11], s28 offen offset:256 nt
    buffer_load_dwordx4 v[120:123], v49, s[8:11], s28 offen offset:512 nt
    buffer_load_dwordx4 v[124:127], v49, s[8:11], s28 offen offset:768 nt
    s_add_u32 s28, s28, s68
    s_branch L_dyn
L_tkslow:
    s_mov_b32 s92, 20000
L_tkslow2:
    s_sleep 2
    s_mov_b64 exec, 1
    v_mov_b32 v53, 1
    buffer_atomic_add v53, v52, s[24:27], s69 offen sc0
    s_mov_b64 exec, -1
    s_waitcnt vmcnt(0)
    v_readfirstlane_b32 s62, v53
    s_sub_u32 s92, s92, 1
    s_cmp_eq_u32 s92, 0
    s_cbranch_scc1 L_drain
    s_lshr_b32 s63, s62, 10
    s_cmp_lg_u32 s63, s78
    s_cbranch_scc1 L_tkslow2
    s_branch L_tk
L_drain:
    v_mov_b32 v27, 1
    ds_write_b32 v52, v27 offset:1536
    s_waitcnt vmcnt(12)
    v_mfma_f32_16x16x32_bf16 v[14:17], v[64:67], v[32:35], 0
    v_mfma_f32_16x16x32_bf16 v[14:17], v[68:71], v[36:39], v[14:17]
    v_mfma_f32_16x16x32_bf16 v[14:17], v[72:75], v[40:43], v[14:17]
    v_mfma_f32_16x16x32_bf16 v[14:17], v[76:79], v[44:47], v[14:17]
    s_nop 7
    v_max3_f32 v26, v14, v15, v16
    v_max3_f32 v26, v26, v17, v12
    v_mov_b32 v27, v26
    s_nop 1
    v_permlane16_swap_b32 v26, v27
    s_nop 0
    v_max_f32 v26, v26, v27
    v_mov_b32 v27, v26
    s_nop 1
    v_permlane32_swap_b32 v26, v27
    s_nop 0
    v_max_f32 v26, v26, v27
    v_sub_f32 v27, v12, v26
    v_mul_f32 v27, s32, v27
    v_exp_f32 v27, v27
    v_mov_b32 v12, v26
    v_mul_f32 v26, s32, v26
    v_fma_f32 v14, v14, s32, -v26
    v_fma_f32 v15, v15, s32, -v26
    v_fma_f32 v16, v16, s32, -v26
    v_fma_f32 v17, v17, s32, -v26
    v_exp_f32 v14, v14
    v_exp_f32 v15, v15
    v_exp_f32 v16, v16
    v_exp_f32 v17, v17
    v_mul_f32 v8, v27, v8
    v_mul_f32 v9, v27, v9
    v_mul_f32 v10, v27, v10
    v_mul_f32 v11, v27, v11
    v_add_f32 v28, v14, v15
    v_add_f32 v29, v16, v17
    v_fma_f32 v13, v13, v27, v28
    v_add_f32 v13, v13, v29
    v_cvt_pk_bf16_f32 v14, v14, v14
    v_cvt_pk_bf16_f32 v15, v15, v15
    v_cvt_pk_bf16_f32 v16, v16, v16
    v_cvt_pk_bf16_f32 v17, v17, v17
    s_waitcnt vmcnt(8)
    v_and_b32 v18, v14, v4
    v_and_b32 v19, v14, v5
    v_and_b32 v20, v14, v6
    v_and_b32 v21, v14, v7
    s_nop 1
    v_mfma_f32_16x16x32_bf16 v[8:11], v[80:83], v[18:21], v[8:11]
    v_and_b32 v22, v15, v4
    v_and_b32 v23, v15, v5
    v_and_b32 v24, v15, v6
    v_and_b32 v25, v15, v7
    s_nop 1
    v_mfma_f32_16x16x32_bf16 v[8:11], v[84:87], v[22:25], v[8:11]
    v_and_b32 v18, v16, v4
    v_and_b32 v19, v16, v5
    v_and_b32 v20, v16, v6
    v_and_b32 v21, v16, v7
    s_nop 1
    v_mfma_f32_16x16x32_bf16 v[8:11], v[88:91], v[18:21], v[8:11]
    v_and_b32 v22, v17, v4
    v_and_b32 v23, v17, v5
    v_and_b32 v24, v17, v6
    v_and_b32 v25, v17, v7
    s_nop 1
    v_mfma_f32_16x16x32_bf16 v[8:11], v[92:95], v[22:25], v[8:11]
    s_waitcnt vmcnt(4)
    v_mfma_f32_16x16x32_bf16 v[14:17], v[96:99], v[32:35], 0
    v_mfma_f32_16x16x32_bf16 v[14:17], v[100:103], v[36:39], v[14:17]
    v_mfma_f32_16x16x32_bf16 v[14:17], v[104:107], v[40:43], v[14:17]
    v_mfma_f32_16x16x32_bf16 v[14:17], v[108:111], v[44:47], v[14:17]
    s_nop 7
    v_max3_f32 v26, v14, v15, v16
    v_max3_f32 v26, v26, v17, v12
    v_mov_b32 v27, v26
    s_nop 1
    v_permlane16_swap_b32 v26, v27
    s_nop 0
    v_max_f32 v26, v26, v27
    v_mov_b32 v27, v26
    s_nop 1
    v_permlane32_swap_b32 v26, v27
    s_nop 0
    v_max_f32 v26, v26, v27
    v_sub_f32 v27, v12, v26
    v_mul_f32 v27, s32, v27
    v_exp_f32 v27, v27
    v_mov_b32 v12, v26
    v_mul_f32 v26, s32, v26
    v_fma_f32 v14, v14, s32, -v26
    v_fma_f32 v15, v15, s32, -v26
    v_fma_f32 v16, v16, s32, -v26
    v_fma_f32 v17, v17, s32, -v26
    v_exp_f32 v14, v14
    v_exp_f32 v15, v15
    v_exp_f32 v16, v16
    v_exp_f32 v17, v17
    v_mul_f32 v8, v27, v8
    v_mul_f32 v9, v27, v9
    v_mul_f32 v10, v27, v10
    v_mul_f32 v11, v27, v11
    v_add_f32 v28, v14, v15
    v_add_f32 v29, v16, v17
    v_fma_f32 v13, v13, v27, v28
    v_add_f32 v13, v13, v29
    v_cvt_pk_bf16_f32 v14, v14, v14
    v_cvt_pk_bf16_f32 v15, v15, v15
    v_cvt_pk_bf16_f32 v16, v16, v16
    v_cvt_pk_bf16_f32 v17, v17, v17
    s_waitcnt vmcnt(0)
    v_and_b32 v18, v14, v4
    v_and_b32 v19, v14, v5
    v_and_b32 v20, v14, v6
    v_and_b32 v21, v14, v7
    s_nop 1
    v_mfma_f32_16x16x32_bf16 v[8:11], v[112:115], v[18:21], v[8:11]
    v_and_b32 v22, v15, v4
    v_and_b32 v23, v15, v5
    v_and_b32 v24, v15, v6
    v_and_b32 v25, v15, v7
    s_nop 1
    v_mfma_f32_16x16x32_bf16 v[8:11], v[116:119], v[22:25], v[8:11]
    v_and_b32 v18, v16, v4
    v_and_b32 v19, v16, v5
    v_and_b32 v20, v16, v6
    v_and_b32 v21, v16, v7
    s_nop 1
    v_mfma_f32_16x16x32_bf16 v[8:11], v[120:123], v[18:21], v[8:11]
    v_and_b32 v22, v17, v4
    v_and_b32 v23, v17, v5
    v_and_b32 v24, v17, v6
    v_and_b32 v25, v17, v7
    s_nop 1
    v_mfma_f32_16x16x32_bf16 v[8:11], v[124:127], v[22:25], v[8:11]
    v_mov_b32 v27, v13
    v_mul_f32 v28, s32, v12
    v_bfi_b32 v14, v63, s70, v28
    v_permlane16_swap_b32 v13, v27
    v_sub_f32 v29, v28, v14
    v_add_f32 v13, v13, v27
    v_mov_b32 v27, v13
    v_exp_f32 v29, v29
    v_bfi_b32 v16, v63, s72, v28
    v_permlane32_swap_b32 v13, v27
    s_nop 0
    v_mul_f32 v8, v29, v8
    v_mul_f32 v9, v29, v9
    v_mul_f32 v10, v29, v10
    v_mul_f32 v11, v29, v11
    v_bfi_b32 v8, v63, s70, v8
    v_bfi_b32 v9, v63, s71, v9
    v_bfi_b32 v10, v63, s72, v10
    v_bfi_b32 v11, v63, s73, v11
    v_add_f32 v15, v13, v27
    s_mov_b64 exec, s[74:75]
    buffer_store_dwordx4 v[8:11], v54, s[24:27], s67 offen sc1
    s_mov_b64 exec, -1
    v_mul_f32 v15, v29, v15
    v_bfi_b32 v17, v63, s73, v15
    v_bfi_b32 v15, v63, s71, v15
    s_mov_b64 exec, s[80:81]
    buffer_store_dwordx4 v[14:17], v50, s[24:27], s67 offen offset:512 sc1
    s_mov_b64 exec, -1
L_end:
    s_endpgm
.section .rodata,"a"
.p2align 6
.amdhsa_kernel concat_heads__gqa_block_cached__mha_block_cached__decode_kernel
  .amdhsa_next_free_vgpr 256
  .amdhsa_next_free_sgpr 102
  .amdhsa_accum_offset 256
  .amdhsa_group_segment_fixed_size 0
  .amdhsa_kernarg_size 104
  .amdhsa_user_sgpr_count 2
  .amdhsa_user_sgpr_kernarg_segment_ptr 1
  .amdhsa_system_sgpr_workgroup_id_x 1
  .amdhsa_float_denorm_mode_32 3
.end_amdhsa_kernel
```
